```python
import torch

def _softmax(x, axis=-1):
    return torch.softmax(x, dim=axis)
def _gelu(x):
    return torch.nn.functional.gelu(x, approximate="tanh")
def _silu(x):
    return torch.nn.functional.silu(x)
def _sigmoid(x):
    return torch.sigmoid(x)
def _layernorm(x, axis=-1, eps=1e-5):
    m = x.mean(dim=axis, keepdim=True)
    v = x.var(dim=axis, keepdim=True, unbiased=False)
    return (x - m) / torch.sqrt(v + eps)
def _scatter_add(tgt, idx, src, axis=0):
    return tgt.clone().index_add_(axis, idx, src)
def _segment_sum(src, seg, n):
    out = torch.zeros((n,) + src.shape[1:], dtype=src.dtype)
    return out.index_add_(0, seg, src)
def _pad(x, pw):
    flat = tuple(v for pair in reversed(pw) for v in pair)
    return torch.nn.functional.pad(x, flat)

kernel_name = 'gated_mix__ssm_conv_s4__mixer_token_mlp__prompt'

def setup_inputs():

    _w = (lambda a: (lambda t: t.to(torch.bfloat16) if t.is_floating_point() else t)(torch.as_tensor(a)))
    def _A_setup():
        B, L, D, N = 1, 2048, 512, 128
        A_re = -(lambda _x: torch.exp(torch.as_tensor(_x)))((lambda *s: torch.randn(*s, dtype=torch.bfloat16) * 3.2)(D, N))
        A_im = torch.pi * (lambda *s: torch.randn(*s, dtype=torch.bfloat16) * 0.05)(D, N)
        B_re = (lambda *s: torch.randn(*s, dtype=torch.bfloat16) * 0.1)(D, N)
        B_im = (lambda *s: torch.randn(*s, dtype=torch.bfloat16) * 0.1)(D, N)
        C_re = (lambda *s: torch.randn(*s, dtype=torch.bfloat16) * 0.1)(D, N)
        C_im = (lambda *s: torch.randn(*s, dtype=torch.bfloat16) * 0.1)(D, N)
        log_dt = (lambda *s: torch.randn(*s, dtype=torch.bfloat16) * 0.05)(D) * 0.5 - 4.0
        Dskip = (lambda *s: torch.randn(*s, dtype=torch.bfloat16) * 0.05)(D)
        return {
            "u": _w((lambda *s: torch.randn(*s, dtype=torch.bfloat16) * 0.05)(B, L, D)),
            "A_re": _w(A_re),
            "A_im": _w(A_im),
            "B_re": _w(B_re),
            "B_im": _w(B_im),
            "C_re": _w(C_re),
            "C_im": _w(C_im),
            "log_dt": _w(log_dt),
            "Dskip": _w(Dskip),
        }
    _A_in = _A_setup()

    def _B_setup():
        B, S, D, F = 1, 2048, 512, 1792
        return {
            "x": _w((lambda *s: torch.randn(*s, dtype=torch.bfloat16) * 0.05)(B, S, D)),
            "w1": _w((lambda *s: torch.randn(*s, dtype=torch.bfloat16) * 0.2)(S, F) * (S ** -0.5)),
            "b1": _w((lambda *s: torch.randn(*s, dtype=torch.bfloat16) * 3.2)(F) * 0.02),
            "w2": _w((lambda *s: torch.randn(*s, dtype=torch.bfloat16) * 0.05)(F, S) * (F ** -0.5)),
            "b2": _w((lambda *s: torch.randn(*s, dtype=torch.bfloat16) * 0.1)(S) * 0.02),
        }
    _B_in = _B_setup()

    return {
        "A_u": _A_in["u"],
        "A_A_re": _A_in["A_re"],
        "A_A_im": _A_in["A_im"],
        "A_B_re": _A_in["B_re"],
        "A_B_im": _A_in["B_im"],
        "A_C_re": _A_in["C_re"],
        "A_C_im": _A_in["C_im"],
        "A_log_dt": _A_in["log_dt"],
        "A_Dskip": _A_in["Dskip"],
        "B_x": _B_in["x"],
        "B_w1": _B_in["w1"],
        "B_b1": _B_in["b1"],
        "B_w2": _B_in["w2"],
        "B_b2": _B_in["b2"],
        "gate_w": _w((lambda *s: torch.randn(*s, dtype=torch.bfloat16) * 0.05)(512) * 16.0),
    }

def reference(A_u, A_A_re, A_A_im, A_B_re, A_B_im, A_C_re, A_C_im, A_log_dt, A_Dskip, B_x, B_w1, B_b1, B_w2, B_b2, gate_w):
    def _A_ref(u, A_re, A_im, B_re, B_im, C_re, C_im, log_dt, Dskip):
        Bsz, L, D = u.shape
        dt = torch.exp(log_dt)[:, None]
        A = A_re + 1j * A_im
        Bc = B_re + 1j * B_im
        Cc = C_re + 1j * C_im
        logdA = dt * A
        dB = dt * Bc
        l = (lambda x, dt: x.to(dt))(torch.arange(L), A_re.dtype)
        P = torch.exp(logdA[:, :, None] * l[None, None, :])
        K = torch.einsum("dn,dnl,dn->dl", Cc, P, dB).real
        L2 = 2 * L
        Kp = _pad(K, ((0, 0), (0, L)))
        up = (lambda x, *d: x.permute(*d))(u, 0, 2, 1)
        up = _pad(up, ((0, 0), (0, 0), (0, L)))
        Kf = (lambda x, axes=(-2,-1): torch.fft.rfft2(x.float(), dim=axes))(Kp[:, None, :], axes=(-2, -1))
        Uf = (lambda x, axes=(-2,-1): torch.fft.rfft2(x.float(), dim=axes))(up[:, :, None, :], axes=(-2, -1))
        Yf = Uf * Kf[None, :, :, :]
        y = (lambda x, s, axes=(-2,-1): torch.fft.irfft2(x, s=s, dim=axes).to(torch.bfloat16))(Yf, (1, L2), axes=(-2, -1))[:, :, 0, :L]
        y = (lambda x, *d: x.permute(*d))(y, 0, 2, 1) + u * Dskip[None, None, :]
        return y

    def _B_ref(x, w1, b1, w2, b2):
        B, S, D = x.shape
        h = _layernorm(x, axis=-1)
        u = torch.einsum("bsd,sf->bdf", h, w1) + b1
        u = _gelu(u)
        y = torch.einsum("bdf,fs->bds", u, w2) + b2
        return (lambda x, *d: x.permute(*d))(y, 0, 2, 1)

    x = A_u
    g = _sigmoid((x * gate_w).sum(-1, keepdims=True))
    a = _A_ref(x, A_A_re, A_A_im, A_B_re, A_B_im, A_C_re, A_C_im, A_log_dt, A_Dskip)
    b = _B_ref(x, B_w1, B_b1, B_w2, B_b2)
    return g * a + (1 - g) * b
```

```asm
; @launch kernel=k1_kernel grid=(640,1,1) block=(256,1,1) lds=33792
; @launch kernel=k2_kernel grid=(480,1,1) block=(256,1,1) lds=65536
; @launch kernel=k3_kernel grid=(256,1,1) block=(256,1,1) lds=65536
.amdgcn_target "amdgcn-amd-amdhsa--gfx950"
.text
.globl k1_kernel
.type k1_kernel,@function
.globl k2_kernel
.type k2_kernel,@function
.globl k3_kernel
.type k3_kernel,@function
.p2align 8
k1_kernel:
    s_cmp_ge_u32 s2, 640
    s_cbranch_scc1 k1_done
    s_load_dwordx2 s[8:9], s[0:1], 136
    s_cmp_ge_u32 s2, 128
    s_cbranch_scc1 k1_kgen
    s_load_dwordx2 s[4:5], s[0:1], 0
    s_load_dwordx2 s[6:7], s[0:1], 112
    v_lshrrev_b32 v1, 4, v0
    v_and_b32 v2, 15, v0
    s_lshl_b32 s3, s2, 4
    v_add_u32 v3, s3, v1
    v_lshlrev_b32 v3, 10, v3
    v_lshl_add_u32 v3, v2, 4, v3
    v_lshlrev_b32 v4, 4, v2
    s_waitcnt lgkmcnt(0)
    s_mov_b32 s12, s4
    s_and_b32 s13, s5, 0xffff
    s_mov_b32 s14, 2097152
    s_mov_b32 s15, 0x00020000
    s_mov_b32 s16, s6
    s_and_b32 s17, s7, 0xffff
    s_mov_b32 s18, 1024
    s_mov_b32 s19, 0x00020000
    s_mov_b32 s20, s8
    s_and_b32 s21, s9, 0xffff
    s_mov_b32 s22, 12910592
    s_mov_b32 s23, 0x00020000
    buffer_load_dwordx4 v[8:11], v3, s[12:15], 0 offen offset:0
    buffer_load_dwordx4 v[12:15], v3, s[12:15], 0 offen offset:256
    buffer_load_dwordx4 v[16:19], v3, s[12:15], 0 offen offset:512
    buffer_load_dwordx4 v[20:23], v3, s[12:15], 0 offen offset:768
    buffer_load_dwordx4 v[24:27], v4, s[16:19], 0 offen offset:0
    buffer_load_dwordx4 v[28:31], v4, s[16:19], 0 offen offset:256
    buffer_load_dwordx4 v[32:35], v4, s[16:19], 0 offen offset:512
    buffer_load_dwordx4 v[36:39], v4, s[16:19], 0 offen offset:768
    v_mul_u32_u24 v5, 1056, v1
    v_lshl_add_u32 v5, v2, 4, v5
    v_mov_b32 v72, 0
    v_mov_b32 v73, 0
    s_mov_b32 s24, 0xffff0000
    s_waitcnt vmcnt(4)
    ds_write_b128 v5, v[8:11] offset:0
    ds_write_b128 v5, v[12:15] offset:256
    ds_write_b128 v5, v[16:19] offset:512
    ds_write_b128 v5, v[20:23] offset:768
    v_lshlrev_b32 v40, 16, v8
    v_and_b32 v41, s24, v8
    v_lshlrev_b32 v42, 16, v9
    v_and_b32 v43, s24, v9
    v_lshlrev_b32 v44, 16, v10
    v_and_b32 v45, s24, v10
    v_lshlrev_b32 v46, 16, v11
    v_and_b32 v47, s24, v11
    v_lshlrev_b32 v48, 16, v12
    v_and_b32 v49, s24, v12
    v_lshlrev_b32 v50, 16, v13
    v_and_b32 v51, s24, v13
    v_lshlrev_b32 v52, 16, v14
    v_and_b32 v53, s24, v14
    v_lshlrev_b32 v54, 16, v15
    v_and_b32 v55, s24, v15
    v_lshlrev_b32 v56, 16, v16
    v_and_b32 v57, s24, v16
    v_lshlrev_b32 v58, 16, v17
    v_and_b32 v59, s24, v17
    v_lshlrev_b32 v60, 16, v18
    v_and_b32 v61, s24, v18
    v_lshlrev_b32 v62, 16, v19
    v_and_b32 v63, s24, v19
    v_lshlrev_b32 v64, 16, v20
    v_and_b32 v65, s24, v20
    v_lshlrev_b32 v66, 16, v21
    v_and_b32 v67, s24, v21
    v_lshlrev_b32 v68, 16, v22
    v_and_b32 v69, s24, v22
    v_lshlrev_b32 v70, 16, v23
    v_and_b32 v71, s24, v23
    v_add_f32 v72, v72, v40
    v_add_f32 v73, v73, v41
    v_add_f32 v72, v72, v42
    v_add_f32 v73, v73, v43
    v_add_f32 v72, v72, v44
    v_add_f32 v73, v73, v45
    v_add_f32 v72, v72, v46
    v_add_f32 v73, v73, v47
    v_add_f32 v72, v72, v48
    v_add_f32 v73, v73, v49
    v_add_f32 v72, v72, v50
    v_add_f32 v73, v73, v51
    v_add_f32 v72, v72, v52
    v_add_f32 v73, v73, v53
    v_add_f32 v72, v72, v54
    v_add_f32 v73, v73, v55
    v_add_f32 v72, v72, v56
    v_add_f32 v73, v73, v57
    v_add_f32 v72, v72, v58
    v_add_f32 v73, v73, v59
    v_add_f32 v72, v72, v60
    v_add_f32 v73, v73, v61
    v_add_f32 v72, v72, v62
    v_add_f32 v73, v73, v63
    v_add_f32 v72, v72, v64
    v_add_f32 v73, v73, v65
    v_add_f32 v72, v72, v66
    v_add_f32 v73, v73, v67
    v_add_f32 v72, v72, v68
    v_add_f32 v73, v73, v69
    v_add_f32 v72, v72, v70
    v_add_f32 v73, v73, v71
    v_add_f32 v72, v72, v73
    v_mov_b32 v73, 0
    s_nop 1
    v_add_f32_dpp v78, v72, v72 quad_perm:[1,0,3,2] row_mask:0xf bank_mask:0xf
    v_mov_b32 v72, v78
    s_nop 1
    v_add_f32_dpp v78, v72, v72 quad_perm:[2,3,0,1] row_mask:0xf bank_mask:0xf
    v_mov_b32 v72, v78
    s_nop 1
    v_add_f32_dpp v78, v72, v72 row_half_mirror row_mask:0xf bank_mask:0xf
    v_mov_b32 v72, v78
    s_nop 1
    v_add_f32_dpp v78, v72, v72 row_mirror row_mask:0xf bank_mask:0xf
    v_mov_b32 v72, v78
    v_mul_f32 v72, 0x3b000000, v72
    v_mov_b32 v79, 0
    v_mov_b32 v77, 0
    v_sub_f32 v74, v40, v72
    v_sub_f32 v75, v41, v72
    v_fmac_f32 v79, v74, v74
    v_fmac_f32 v77, v75, v75
    v_sub_f32 v74, v42, v72
    v_sub_f32 v75, v43, v72
    v_fmac_f32 v79, v74, v74
    v_fmac_f32 v77, v75, v75
    v_sub_f32 v74, v44, v72
    v_sub_f32 v75, v45, v72
    v_fmac_f32 v79, v74, v74
    v_fmac_f32 v77, v75, v75
    v_sub_f32 v74, v46, v72
    v_sub_f32 v75, v47, v72
    v_fmac_f32 v79, v74, v74
    v_fmac_f32 v77, v75, v75
    v_sub_f32 v74, v48, v72
    v_sub_f32 v75, v49, v72
    v_fmac_f32 v79, v74, v74
    v_fmac_f32 v77, v75, v75
    v_sub_f32 v74, v50, v72
    v_sub_f32 v75, v51, v72
    v_fmac_f32 v79, v74, v74
    v_fmac_f32 v77, v75, v75
    v_sub_f32 v74, v52, v72
    v_sub_f32 v75, v53, v72
    v_fmac_f32 v79, v74, v74
    v_fmac_f32 v77, v75, v75
    v_sub_f32 v74, v54, v72
    v_sub_f32 v75, v55, v72
    v_fmac_f32 v79, v74, v74
    v_fmac_f32 v77, v75, v75
    v_sub_f32 v74, v56, v72
    v_sub_f32 v75, v57, v72
    v_fmac_f32 v79, v74, v74
    v_fmac_f32 v77, v75, v75
    v_sub_f32 v74, v58, v72
    v_sub_f32 v75, v59, v72
    v_fmac_f32 v79, v74, v74
    v_fmac_f32 v77, v75, v75
    v_sub_f32 v74, v60, v72
    v_sub_f32 v75, v61, v72
    v_fmac_f32 v79, v74, v74
    v_fmac_f32 v77, v75, v75
    v_sub_f32 v74, v62, v72
    v_sub_f32 v75, v63, v72
    v_fmac_f32 v79, v74, v74
    v_fmac_f32 v77, v75, v75
    v_sub_f32 v74, v64, v72
    v_sub_f32 v75, v65, v72
    v_fmac_f32 v79, v74, v74
    v_fmac_f32 v77, v75, v75
    v_sub_f32 v74, v66, v72
    v_sub_f32 v75, v67, v72
    v_fmac_f32 v79, v74, v74
    v_fmac_f32 v77, v75, v75
    v_sub_f32 v74, v68, v72
    v_sub_f32 v75, v69, v72
    v_fmac_f32 v79, v74, v74
    v_fmac_f32 v77, v75, v75
    v_sub_f32 v74, v70, v72
    v_sub_f32 v75, v71, v72
    v_fmac_f32 v79, v74, v74
    v_fmac_f32 v77, v75, v75
    v_add_f32 v79, v79, v77
    s_nop 1
    v_add_f32_dpp v78, v79, v79 quad_perm:[1,0,3,2] row_mask:0xf bank_mask:0xf
    v_mov_b32 v79, v78
    s_nop 1
    v_add_f32_dpp v78, v79, v79 quad_perm:[2,3,0,1] row_mask:0xf bank_mask:0xf
    v_mov_b32 v79, v78
    s_nop 1
    v_add_f32_dpp v78, v79, v79 row_half_mirror row_mask:0xf bank_mask:0xf
    v_mov_b32 v79, v78
    s_nop 1
    v_add_f32_dpp v78, v79, v79 row_mirror row_mask:0xf bank_mask:0xf
    v_mov_b32 v79, v78
    v_mul_f32 v79, 0x3b000000, v79
    s_waitcnt vmcnt(0)
    v_lshlrev_b32 v76, 16, v24
    v_and_b32 v77, s24, v24
    v_mul_f32 v76, v40, v76
    v_mul_f32 v77, v41, v77
    v_cvt_pk_bf16_f32 v76, v76, v77
    v_lshlrev_b32 v77, 16, v76
    v_and_b32 v76, s24, v76
    v_add_f32 v73, v73, v77
    v_add_f32 v73, v73, v76
    v_lshlrev_b32 v76, 16, v25
    v_and_b32 v77, s24, v25
    v_mul_f32 v76, v42, v76
    v_mul_f32 v77, v43, v77
    v_cvt_pk_bf16_f32 v76, v76, v77
    v_lshlrev_b32 v77, 16, v76
    v_and_b32 v76, s24, v76
    v_add_f32 v73, v73, v77
    v_add_f32 v73, v73, v76
    v_lshlrev_b32 v76, 16, v26
    v_and_b32 v77, s24, v26
    v_mul_f32 v76, v44, v76
    v_mul_f32 v77, v45, v77
    v_cvt_pk_bf16_f32 v76, v76, v77
    v_lshlrev_b32 v77, 16, v76
    v_and_b32 v76, s24, v76
    v_add_f32 v73, v73, v77
    v_add_f32 v73, v73, v76
    v_lshlrev_b32 v76, 16, v27
    v_and_b32 v77, s24, v27
    v_mul_f32 v76, v46, v76
    v_mul_f32 v77, v47, v77
    v_cvt_pk_bf16_f32 v76, v76, v77
    v_lshlrev_b32 v77, 16, v76
    v_and_b32 v76, s24, v76
    v_add_f32 v73, v73, v77
    v_add_f32 v73, v73, v76
    v_lshlrev_b32 v76, 16, v28
    v_and_b32 v77, s24, v28
    v_mul_f32 v76, v48, v76
    v_mul_f32 v77, v49, v77
    v_cvt_pk_bf16_f32 v76, v76, v77
    v_lshlrev_b32 v77, 16, v76
    v_and_b32 v76, s24, v76
    v_add_f32 v73, v73, v77
    v_add_f32 v73, v73, v76
    v_lshlrev_b32 v76, 16, v29
    v_and_b32 v77, s24, v29
    v_mul_f32 v76, v50, v76
    v_mul_f32 v77, v51, v77
    v_cvt_pk_bf16_f32 v76, v76, v77
    v_lshlrev_b32 v77, 16, v76
    v_and_b32 v76, s24, v76
    v_add_f32 v73, v73, v77
    v_add_f32 v73, v73, v76
    v_lshlrev_b32 v76, 16, v30
    v_and_b32 v77, s24, v30
    v_mul_f32 v76, v52, v76
    v_mul_f32 v77, v53, v77
    v_cvt_pk_bf16_f32 v76, v76, v77
    v_lshlrev_b32 v77, 16, v76
    v_and_b32 v76, s24, v76
    v_add_f32 v73, v73, v77
    v_add_f32 v73, v73, v76
    v_lshlrev_b32 v76, 16, v31
    v_and_b32 v77, s24, v31
    v_mul_f32 v76, v54, v76
    v_mul_f32 v77, v55, v77
    v_cvt_pk_bf16_f32 v76, v76, v77
    v_lshlrev_b32 v77, 16, v76
    v_and_b32 v76, s24, v76
    v_add_f32 v73, v73, v77
    v_add_f32 v73, v73, v76
    v_lshlrev_b32 v76, 16, v32
    v_and_b32 v77, s24, v32
    v_mul_f32 v76, v56, v76
    v_mul_f32 v77, v57, v77
    v_cvt_pk_bf16_f32 v76, v76, v77
    v_lshlrev_b32 v77, 16, v76
    v_and_b32 v76, s24, v76
    v_add_f32 v73, v73, v77
    v_add_f32 v73, v73, v76
    v_lshlrev_b32 v76, 16, v33
    v_and_b32 v77, s24, v33
    v_mul_f32 v76, v58, v76
    v_mul_f32 v77, v59, v77
    v_cvt_pk_bf16_f32 v76, v76, v77
    v_lshlrev_b32 v77, 16, v76
    v_and_b32 v76, s24, v76
    v_add_f32 v73, v73, v77
    v_add_f32 v73, v73, v76
    v_lshlrev_b32 v76, 16, v34
    v_and_b32 v77, s24, v34
    v_mul_f32 v76, v60, v76
    v_mul_f32 v77, v61, v77
    v_cvt_pk_bf16_f32 v76, v76, v77
    v_lshlrev_b32 v77, 16, v76
    v_and_b32 v76, s24, v76
    v_add_f32 v73, v73, v77
    v_add_f32 v73, v73, v76
    v_lshlrev_b32 v76, 16, v35
    v_and_b32 v77, s24, v35
    v_mul_f32 v76, v62, v76
    v_mul_f32 v77, v63, v77
    v_cvt_pk_bf16_f32 v76, v76, v77
    v_lshlrev_b32 v77, 16, v76
    v_and_b32 v76, s24, v76
    v_add_f32 v73, v73, v77
    v_add_f32 v73, v73, v76
    v_lshlrev_b32 v76, 16, v36
    v_and_b32 v77, s24, v36
    v_mul_f32 v76, v64, v76
    v_mul_f32 v77, v65, v77
    v_cvt_pk_bf16_f32 v76, v76, v77
    v_lshlrev_b32 v77, 16, v76
    v_and_b32 v76, s24, v76
    v_add_f32 v73, v73, v77
    v_add_f32 v73, v73, v76
    v_lshlrev_b32 v76, 16, v37
    v_and_b32 v77, s24, v37
    v_mul_f32 v76, v66, v76
    v_mul_f32 v77, v67, v77
    v_cvt_pk_bf16_f32 v76, v76, v77
    v_lshlrev_b32 v77, 16, v76
    v_and_b32 v76, s24, v76
    v_add_f32 v73, v73, v77
    v_add_f32 v73, v73, v76
    v_lshlrev_b32 v76, 16, v38
    v_and_b32 v77, s24, v38
    v_mul_f32 v76, v68, v76
    v_mul_f32 v77, v69, v77
    v_cvt_pk_bf16_f32 v76, v76, v77
    v_lshlrev_b32 v77, 16, v76
    v_and_b32 v76, s24, v76
    v_add_f32 v73, v73, v77
    v_add_f32 v73, v73, v76
    v_lshlrev_b32 v76, 16, v39
    v_and_b32 v77, s24, v39
    v_mul_f32 v76, v70, v76
    v_mul_f32 v77, v71, v77
    v_cvt_pk_bf16_f32 v76, v76, v77
    v_lshlrev_b32 v77, 16, v76
    v_and_b32 v76, s24, v76
    v_add_f32 v73, v73, v77
    v_add_f32 v73, v73, v76
    s_nop 1
    v_add_f32_dpp v78, v73, v73 quad_perm:[1,0,3,2] row_mask:0xf bank_mask:0xf
    v_mov_b32 v73, v78
    s_nop 1
    v_add_f32_dpp v78, v73, v73 quad_perm:[2,3,0,1] row_mask:0xf bank_mask:0xf
    v_mov_b32 v73, v78
    s_nop 1
    v_add_f32_dpp v78, v73, v73 row_half_mirror row_mask:0xf bank_mask:0xf
    v_mov_b32 v73, v78
    s_nop 1
    v_add_f32_dpp v78, v73, v73 row_mirror row_mask:0xf bank_mask:0xf
    v_mov_b32 v73, v78
    v_cvt_pk_bf16_f32 v74, v72, v79
    v_lshlrev_b32 v72, 16, v74
    v_and_b32 v79, s24, v74
    v_add_f32 v79, 0x3727c5ac, v79
    v_cvt_pk_bf16_f32 v74, v79, v73
    v_lshlrev_b32 v79, 16, v74
    v_and_b32 v73, s24, v74
    v_sqrt_f32 v79, v79
    v_mul_f32 v73, 0xbfb8aa3b, v73
    v_exp_f32 v73, v73
    v_cvt_pk_bf16_f32 v74, v79, v79
    v_lshlrev_b32 v79, 16, v74
    v_add_f32 v73, 1.0, v73
    v_rcp_f32 v79, v79
    v_rcp_f32 v73, v73
    s_nop 0
    v_cvt_pk_bf16_f32 v74, v73, v73
    v_lshlrev_b32 v73, 16, v74
    v_add_u32 v6, s3, v1
    v_lshlrev_b32 v6, 2, v6
    v_cmp_eq_u32 vcc, 0, v2
    s_and_saveexec_b64 s[26:27], vcc
    s_mov_b32 s25, 4194304
    buffer_store_dword v73, v6, s[20:23], s25 offen sc1
    s_mov_b64 exec, s[26:27]
    v_sub_f32 v74, v40, v72
    v_sub_f32 v75, v41, v72
    v_cvt_pk_bf16_f32 v74, v74, v75
    v_lshlrev_b32 v75, 16, v74
    v_and_b32 v74, s24, v74
    v_mul_f32 v75, v75, v79
    v_mul_f32 v74, v74, v79
    v_cvt_pk_bf16_f32 v24, v75, v74
    v_sub_f32 v74, v42, v72
    v_sub_f32 v75, v43, v72
    v_cvt_pk_bf16_f32 v74, v74, v75
    v_lshlrev_b32 v75, 16, v74
    v_and_b32 v74, s24, v74
    v_mul_f32 v75, v75, v79
    v_mul_f32 v74, v74, v79
    v_cvt_pk_bf16_f32 v25, v75, v74
    v_sub_f32 v74, v44, v72
    v_sub_f32 v75, v45, v72
    v_cvt_pk_bf16_f32 v74, v74, v75
    v_lshlrev_b32 v75, 16, v74
    v_and_b32 v74, s24, v74
    v_mul_f32 v75, v75, v79
    v_mul_f32 v74, v74, v79
    v_cvt_pk_bf16_f32 v26, v75, v74
    v_sub_f32 v74, v46, v72
    v_sub_f32 v75, v47, v72
    v_cvt_pk_bf16_f32 v74, v74, v75
    v_lshlrev_b32 v75, 16, v74
    v_and_b32 v74, s24, v74
    v_mul_f32 v75, v75, v79
    v_mul_f32 v74, v74, v79
    v_cvt_pk_bf16_f32 v27, v75, v74
    v_sub_f32 v74, v48, v72
    v_sub_f32 v75, v49, v72
    v_cvt_pk_bf16_f32 v74, v74, v75
    v_lshlrev_b32 v75, 16, v74
    v_and_b32 v74, s24, v74
    v_mul_f32 v75, v75, v79
    v_mul_f32 v74, v74, v79
    v_cvt_pk_bf16_f32 v28, v75, v74
    v_sub_f32 v74, v50, v72
    v_sub_f32 v75, v51, v72
    v_cvt_pk_bf16_f32 v74, v74, v75
    v_lshlrev_b32 v75, 16, v74
    v_and_b32 v74, s24, v74
    v_mul_f32 v75, v75, v79
    v_mul_f32 v74, v74, v79
    v_cvt_pk_bf16_f32 v29, v75, v74
    v_sub_f32 v74, v52, v72
    v_sub_f32 v75, v53, v72
    v_cvt_pk_bf16_f32 v74, v74, v75
    v_lshlrev_b32 v75, 16, v74
    v_and_b32 v74, s24, v74
    v_mul_f32 v75, v75, v79
    v_mul_f32 v74, v74, v79
    v_cvt_pk_bf16_f32 v30, v75, v74
    v_sub_f32 v74, v54, v72
    v_sub_f32 v75, v55, v72
    v_cvt_pk_bf16_f32 v74, v74, v75
    v_lshlrev_b32 v75, 16, v74
    v_and_b32 v74, s24, v74
    v_mul_f32 v75, v75, v79
    v_mul_f32 v74, v74, v79
    v_cvt_pk_bf16_f32 v31, v75, v74
    v_sub_f32 v74, v56, v72
    v_sub_f32 v75, v57, v72
    v_cvt_pk_bf16_f32 v74, v74, v75
    v_lshlrev_b32 v75, 16, v74
    v_and_b32 v74, s24, v74
    v_mul_f32 v75, v75, v79
    v_mul_f32 v74, v74, v79
    v_cvt_pk_bf16_f32 v32, v75, v74
    v_sub_f32 v74, v58, v72
    v_sub_f32 v75, v59, v72
    v_cvt_pk_bf16_f32 v74, v74, v75
    v_lshlrev_b32 v75, 16, v74
    v_and_b32 v74, s24, v74
    v_mul_f32 v75, v75, v79
    v_mul_f32 v74, v74, v79
    v_cvt_pk_bf16_f32 v33, v75, v74
    v_sub_f32 v74, v60, v72
    v_sub_f32 v75, v61, v72
    v_cvt_pk_bf16_f32 v74, v74, v75
    v_lshlrev_b32 v75, 16, v74
    v_and_b32 v74, s24, v74
    v_mul_f32 v75, v75, v79
    v_mul_f32 v74, v74, v79
    v_cvt_pk_bf16_f32 v34, v75, v74
    v_sub_f32 v74, v62, v72
    v_sub_f32 v75, v63, v72
    v_cvt_pk_bf16_f32 v74, v74, v75
    v_lshlrev_b32 v75, 16, v74
    v_and_b32 v74, s24, v74
    v_mul_f32 v75, v75, v79
    v_mul_f32 v74, v74, v79
    v_cvt_pk_bf16_f32 v35, v75, v74
    v_sub_f32 v74, v64, v72
    v_sub_f32 v75, v65, v72
    v_cvt_pk_bf16_f32 v74, v74, v75
    v_lshlrev_b32 v75, 16, v74
    v_and_b32 v74, s24, v74
    v_mul_f32 v75, v75, v79
    v_mul_f32 v74, v74, v79
    v_cvt_pk_bf16_f32 v36, v75, v74
    v_sub_f32 v74, v66, v72
    v_sub_f32 v75, v67, v72
    v_cvt_pk_bf16_f32 v74, v74, v75
    v_lshlrev_b32 v75, 16, v74
    v_and_b32 v74, s24, v74
    v_mul_f32 v75, v75, v79
    v_mul_f32 v74, v74, v79
    v_cvt_pk_bf16_f32 v37, v75, v74
    v_sub_f32 v74, v68, v72
    v_sub_f32 v75, v69, v72
    v_cvt_pk_bf16_f32 v74, v74, v75
    v_lshlrev_b32 v75, 16, v74
    v_and_b32 v74, s24, v74
    v_mul_f32 v75, v75, v79
    v_mul_f32 v74, v74, v79
    v_cvt_pk_bf16_f32 v38, v75, v74
    v_sub_f32 v74, v70, v72
    v_sub_f32 v75, v71, v72
    v_cvt_pk_bf16_f32 v74, v74, v75
    v_lshlrev_b32 v75, 16, v74
    v_and_b32 v74, s24, v74
    v_mul_f32 v75, v75, v79
    v_mul_f32 v74, v74, v79
    v_cvt_pk_bf16_f32 v39, v75, v74
    ds_write_b128 v5, v[24:27] offset:16896
    ds_write_b128 v5, v[28:31] offset:17152
    ds_write_b128 v5, v[32:35] offset:17408
    ds_write_b128 v5, v[36:39] offset:17664
    v_lshrrev_b32 v1, 6, v0
    v_bfe_u32 v2, v0, 4, 1
    v_bfe_u32 v9, v0, 5, 1
    v_and_b32 v3, 15, v0
    v_lshrrev_b32 v4, 2, v3
    v_and_b32 v5, 3, v0
    v_lshl_add_u32 v6, v2, 3, v4
    v_mul_u32_u24 v6, 1056, v6
    v_lshl_add_u32 v6, v1, 8, v6
    v_lshl_add_u32 v6, v9, 5, v6
    v_lshl_add_u32 v6, v5, 3, v6
    v_lshl_add_u32 v7, v1, 9, v2
    v_lshlrev_b32 v7, 10, v7
    v_lshl_add_u32 v7, v3, 4, v7
    v_lshl_add_u32 v7, v9, 8, v7
    s_lshl_b32 s25, s2, 11
    v_add_u32 v7, s25, v7
    v_lshl_add_u32 v8, v1, 7, v3
    v_lshl_add_u32 v8, v9, 4, v8
    v_lshlrev_b32 v8, 12, v8
    v_lshl_add_u32 v8, v2, 4, v8
    s_lshl_b32 s25, s2, 5
    v_add_u32 v8, s25, v8
    s_waitcnt lgkmcnt(0)
    s_barrier
    ds_read_b64_tr_b16 v[12:13], v6 offset:16896
    ds_read_b64_tr_b16 v[14:15], v6 offset:21120
    ds_read_b64_tr_b16 v[16:17], v6 offset:0
    ds_read_b64_tr_b16 v[18:19], v6 offset:4224
    ds_read_b64_tr_b16 v[20:21], v6 offset:16960
    ds_read_b64_tr_b16 v[22:23], v6 offset:21184
    ds_read_b64_tr_b16 v[24:25], v6 offset:64
    ds_read_b64_tr_b16 v[26:27], v6 offset:4288
    ds_read_b64_tr_b16 v[28:29], v6 offset:17024
    ds_read_b64_tr_b16 v[30:31], v6 offset:21248
    ds_read_b64_tr_b16 v[32:33], v6 offset:128
    ds_read_b64_tr_b16 v[34:35], v6 offset:4352
    ds_read_b64_tr_b16 v[36:37], v6 offset:17088
    ds_read_b64_tr_b16 v[38:39], v6 offset:21312
    ds_read_b64_tr_b16 v[40:41], v6 offset:192
    ds_read_b64_tr_b16 v[42:43], v6 offset:4416
    s_mov_b32 s25, 0
    s_mov_b32 s28, 2097152
    s_waitcnt lgkmcnt(12)
    buffer_store_dwordx4 v[12:15], v7, s[20:23], s25 offen offset:0 sc1
    buffer_store_dwordx4 v[16:19], v8, s[20:23], s28 offen sc1
    s_mov_b32 s25, 0
    s_mov_b32 s28, 2228224
    s_waitcnt lgkmcnt(8)
    buffer_store_dwordx4 v[20:23], v7, s[20:23], s25 offen offset:512 sc1
    buffer_store_dwordx4 v[24:27], v8, s[20:23], s28 offen sc1
    s_mov_b32 s25, 262144
    s_mov_b32 s28, 2359296
    s_waitcnt lgkmcnt(4)
    buffer_store_dwordx4 v[28:31], v7, s[20:23], s25 offen offset:0 sc1
    buffer_store_dwordx4 v[32:35], v8, s[20:23], s28 offen sc1
    s_mov_b32 s25, 262144
    s_mov_b32 s28, 2490368
    s_waitcnt lgkmcnt(0)
    buffer_store_dwordx4 v[36:39], v7, s[20:23], s25 offen offset:512 sc1
    buffer_store_dwordx4 v[40:43], v8, s[20:23], s28 offen sc1
    s_branch k1_done
k1_kgen:
    s_sub_u32 s3, s2, 128
    s_load_dwordx4 s[12:15], s[0:1], 8
    s_load_dwordx4 s[16:19], s[0:1], 24
    s_load_dwordx4 s[24:27], s[0:1], 40
    s_load_dwordx2 s[28:29], s[0:1], 56
    s_load_dwordx2 s[32:33], s[0:1], 80
    s_load_dwordx2 s[44:45], s[0:1], 96
    v_and_b32 v1, 15, v0
    v_bfe_u32 v2, v0, 4, 2
    v_lshrrev_b32 v3, 6, v0
    v_lshlrev_b32 v4, 6, v3
    v_lshl_add_u32 v4, v2, 4, v4
    s_lshl_b32 s4, s3, 8
    v_add_u32 v4, s4, v4
    s_lshl_b32 s5, s3, 1
    v_mov_b32 v5, s5
    v_lshlrev_b32 v6, 4, v0
    s_lshl_b32 s34, s3, 14
    s_waitcnt lgkmcnt(0)
    s_mov_b32 s20, s8
    s_and_b32 s21, s9, 0xffff
    s_mov_b32 s22, 12910592
    s_mov_b32 s23, 0x00020000
    s_mov_b32 s36, s32
    s_and_b32 s37, s33, 0xffff
    s_mov_b32 s38, 7340032
    s_mov_b32 s39, 0x00020000
    s_mov_b32 s40, s44
    s_and_b32 s41, s45, 0xffff
    s_mov_b32 s42, 7340032
    s_mov_b32 s43, 0x00020000
    global_load_dwordx4 v[8:11], v4, s[12:13]
    global_load_dwordx4 v[12:15], v4, s[14:15]
    global_load_dwordx4 v[16:19], v4, s[16:17]
    global_load_dwordx4 v[20:23], v4, s[18:19]
    global_load_dwordx4 v[24:27], v4, s[24:25]
    global_load_dwordx4 v[28:31], v4, s[26:27]
    global_load_ushort v7, v5, s[28:29]
    v_lshlrev_b32 v40, 3, v1
    v_cvt_f32_u32 v40, v40
    v_and_b32 v41, 7, v1
    v_lshrrev_b32 v42, 3, v1
    v_lshl_add_u32 v41, v42, 7, v41
    v_cvt_f32_u32 v41, v41
    v_and_b32 v42, 3, v1
    v_lshlrev_b32 v42, 1, v42
    v_lshrrev_b32 v43, 2, v1
    v_lshl_add_u32 v42, v43, 7, v42
    v_add_u32 v42, 256, v42
    v_and_b32 v43, 1, v1
    v_lshlrev_b32 v43, 2, v43
    v_bfe_u32 v44, v1, 1, 2
    v_lshl_add_u32 v43, v44, 7, v43
    v_add_u32 v43, 512, v43
    v_cmp_gt_u32 vcc, 8, v1
    s_nop 1
    v_cndmask_b32 v42, v43, v42, vcc
    v_cvt_f32_u32 v42, v42
    v_min_u32 v43, 8, v1
    v_lshlrev_b32 v43, 7, v43
    v_add_u32 v43, 1024, v43
    v_cvt_f32_u32 v43, v43
    v_mov_b32 v76, 0
    v_mov_b32 v77, 0
    v_mov_b32 v78, 0
    v_mov_b32 v79, 0
    v_mov_b32 v80, 0
    v_mov_b32 v81, 0
    v_mov_b32 v82, 0
    v_mov_b32 v83, 0
    v_mov_b32 v84, 0
    v_mov_b32 v85, 0
    v_mov_b32 v86, 0
    v_mov_b32 v87, 0
    s_mov_b32 s30, 0xffff0000
    s_waitcnt vmcnt(0)
    s_mov_b32 s35, s34
    buffer_load_dwordx4 v[104:107], v6, s[36:39], s34 offen
    s_add_u32 s34, s34, 4096
    buffer_load_dwordx4 v[104:107], v6, s[36:39], s34 offen
    s_add_u32 s34, s34, 4096
    buffer_load_dwordx4 v[104:107], v6, s[36:39], s34 offen
    s_add_u32 s34, s34, 4096
    buffer_load_dwordx4 v[104:107], v6, s[36:39], s34 offen
    s_add_u32 s34, s34, 4096
    v_lshlrev_b32 v38, 16, v7
    s_mov_b32 s31, 0x3fb8aa3b
    v_mul_f32 v7, s31, v38
    v_fma_f32 v44, v38, s31, -v7
    v_fmac_f32 v44, 0x32a57060, v38
    v_exp_f32 v7, v7
    v_mul_f32 v44, 0x3f317218, v44
    v_fma_f32 v7, v7, v44, v7
    v_cvt_pk_bf16_f32 v7, v7, v7
    v_lshlrev_b32 v7, 16, v7
    s_mov_b32 s4, 0x3e22f983
    v_mul_f32 v45, s31, v7
    v_mul_f32 v46, s4, v7
    v_lshlrev_b32 v52, 16, v8
    v_lshlrev_b32 v53, 16, v12
    v_lshlrev_b32 v54, 16, v16
    v_lshlrev_b32 v55, 16, v20
    v_lshlrev_b32 v56, 16, v24
    v_lshlrev_b32 v57, 16, v28
    v_mul_f32 v52, v45, v52
    v_mul_f32 v53, v46, v53
    v_mul_f32 v54, v7, v54
    v_mul_f32 v55, v7, v55
    v_mul_f32 v60, v40, v52
    v_mul_f32 v64, v40, v53
    v_mul_f32 v61, v41, v52
    v_mul_f32 v65, v41, v53
    v_mul_f32 v62, v42, v52
    v_mul_f32 v66, v42, v53
    v_mul_f32 v63, v43, v52
    v_mul_f32 v67, v43, v53
    v_exp_f32 v60, v60
    v_fract_f32 v64, v64
    v_exp_f32 v61, v61
    v_fract_f32 v65, v65
    v_exp_f32 v62, v62
    v_fract_f32 v66, v66
    v_exp_f32 v63, v63
    v_fract_f32 v67, v67
    v_sin_f32 v68, v64
    v_cos_f32 v64, v64
    v_mul_f32 v58, v56, v54
    v_sin_f32 v69, v65
    v_cos_f32 v65, v65
    v_mul_f32 v59, v56, v55
    v_sin_f32 v70, v66
    v_cos_f32 v66, v66
    v_fma_f32 v58, -v57, v55, v58
    v_sin_f32 v71, v67
    v_cos_f32 v67, v67
    v_fmac_f32 v59, v57, v54
    v_mul_f32 v68, v60, v68
    v_mul_f32 v64, v60, v64
    v_mul_f32 v69, v61, v69
    v_mul_f32 v65, v61, v65
    v_mul_f32 v70, v62, v70
    v_mul_f32 v66, v62, v66
    v_mul_f32 v71, v63, v71
    v_mul_f32 v67, v63, v67
    v_mul_f32 v72, v58, v64
    v_mul_f32 v73, -v58, v68
    v_fma_f32 v72, -v59, v68, v72
    v_fma_f32 v73, -v59, v64, v73
    v_cvt_pk_bf16_f32 v108, v65, v69
    v_cvt_pk_bf16_f32 v112, v66, v70
    v_cvt_pk_bf16_f32 v116, v67, v71
    v_cvt_pk_bf16_f32 v88, v72, v73
    v_lshlrev_b32 v60, 16, v108
    v_and_b32 v52, s30, v108
    v_lshlrev_b32 v61, 16, v112
    v_and_b32 v53, s30, v112
    v_lshlrev_b32 v62, 16, v116
    v_and_b32 v54, s30, v116
    v_lshlrev_b32 v63, 16, v88
    v_and_b32 v55, s30, v88
    v_sub_f32 v60, v65, v60
    v_sub_f32 v52, v69, v52
    v_sub_f32 v61, v66, v61
    v_sub_f32 v53, v70, v53
    v_sub_f32 v62, v67, v62
    v_sub_f32 v54, v71, v54
    v_sub_f32 v63, v72, v63
    v_sub_f32 v55, v73, v55
    v_cvt_pk_bf16_f32 v120, v60, v52
    v_cvt_pk_bf16_f32 v124, v61, v53
    v_cvt_pk_bf16_f32 v128, v62, v54
    v_cvt_pk_bf16_f32 v92, v63, v55
    v_and_b32 v52, s30, v8
    v_and_b32 v53, s30, v12
    v_and_b32 v54, s30, v16
    v_and_b32 v55, s30, v20
    v_and_b32 v56, s30, v24
    v_and_b32 v57, s30, v28
    v_mul_f32 v52, v45, v52
    v_mul_f32 v53, v46, v53
    v_mul_f32 v54, v7, v54
    v_mul_f32 v55, v7, v55
    v_mul_f32 v60, v40, v52
    v_mul_f32 v64, v40, v53
    v_mul_f32 v61, v41, v52
    v_mul_f32 v65, v41, v53
    v_mul_f32 v62, v42, v52
    v_mul_f32 v66, v42, v53
    v_mul_f32 v63, v43, v52
    v_mul_f32 v67, v43, v53
    v_exp_f32 v60, v60
    v_fract_f32 v64, v64
    v_exp_f32 v61, v61
    v_fract_f32 v65, v65
    v_exp_f32 v62, v62
    v_fract_f32 v66, v66
    v_exp_f32 v63, v63
    v_fract_f32 v67, v67
    v_sin_f32 v68, v64
    v_cos_f32 v64, v64
    v_mul_f32 v58, v56, v54
    v_sin_f32 v69, v65
    v_cos_f32 v65, v65
    v_mul_f32 v59, v56, v55
    v_sin_f32 v70, v66
    v_cos_f32 v66, v66
    v_fma_f32 v58, -v57, v55, v58
    v_sin_f32 v71, v67
    v_cos_f32 v67, v67
    v_fmac_f32 v59, v57, v54
    v_mul_f32 v68, v60, v68
    v_mul_f32 v64, v60, v64
    v_mul_f32 v69, v61, v69
    v_mul_f32 v65, v61, v65
    v_mul_f32 v70, v62, v70
    v_mul_f32 v66, v62, v66
    v_mul_f32 v71, v63, v71
    v_mul_f32 v67, v63, v67
    v_mul_f32 v72, v58, v64
    v_mul_f32 v73, -v58, v68
    v_fma_f32 v72, -v59, v68, v72
    v_fma_f32 v73, -v59, v64, v73
    v_cvt_pk_bf16_f32 v109, v65, v69
    v_cvt_pk_bf16_f32 v113, v66, v70
    v_cvt_pk_bf16_f32 v117, v67, v71
    v_cvt_pk_bf16_f32 v89, v72, v73
    v_lshlrev_b32 v60, 16, v109
    v_and_b32 v52, s30, v109
    v_lshlrev_b32 v61, 16, v113
    v_and_b32 v53, s30, v113
    v_lshlrev_b32 v62, 16, v117
    v_and_b32 v54, s30, v117
    v_lshlrev_b32 v63, 16, v89
    v_and_b32 v55, s30, v89
    v_sub_f32 v60, v65, v60
    v_sub_f32 v52, v69, v52
    v_sub_f32 v61, v66, v61
    v_sub_f32 v53, v70, v53
    v_sub_f32 v62, v67, v62
    v_sub_f32 v54, v71, v54
    v_sub_f32 v63, v72, v63
    v_sub_f32 v55, v73, v55
    v_cvt_pk_bf16_f32 v121, v60, v52
    v_cvt_pk_bf16_f32 v125, v61, v53
    v_cvt_pk_bf16_f32 v129, v62, v54
    v_cvt_pk_bf16_f32 v93, v63, v55
    v_lshlrev_b32 v52, 16, v9
    v_lshlrev_b32 v53, 16, v13
    v_lshlrev_b32 v54, 16, v17
    v_lshlrev_b32 v55, 16, v21
    v_lshlrev_b32 v56, 16, v25
    v_lshlrev_b32 v57, 16, v29
    v_mul_f32 v52, v45, v52
    v_mul_f32 v53, v46, v53
    v_mul_f32 v54, v7, v54
    v_mul_f32 v55, v7, v55
    v_mul_f32 v60, v40, v52
    v_mul_f32 v64, v40, v53
    v_mul_f32 v61, v41, v52
    v_mul_f32 v65, v41, v53
    v_mul_f32 v62, v42, v52
    v_mul_f32 v66, v42, v53
    v_mul_f32 v63, v43, v52
    v_mul_f32 v67, v43, v53
    v_exp_f32 v60, v60
    v_fract_f32 v64, v64
    v_exp_f32 v61, v61
    v_fract_f32 v65, v65
    v_exp_f32 v62, v62
    v_fract_f32 v66, v66
    v_exp_f32 v63, v63
    v_fract_f32 v67, v67
    v_sin_f32 v68, v64
    v_cos_f32 v64, v64
    v_mul_f32 v58, v56, v54
    v_sin_f32 v69, v65
    v_cos_f32 v65, v65
    v_mul_f32 v59, v56, v55
    v_sin_f32 v70, v66
    v_cos_f32 v66, v66
    v_fma_f32 v58, -v57, v55, v58
    v_sin_f32 v71, v67
    v_cos_f32 v67, v67
    v_fmac_f32 v59, v57, v54
    v_mul_f32 v68, v60, v68
    v_mul_f32 v64, v60, v64
    v_mul_f32 v69, v61, v69
    v_mul_f32 v65, v61, v65
    v_mul_f32 v70, v62, v70
    v_mul_f32 v66, v62, v66
    v_mul_f32 v71, v63, v71
    v_mul_f32 v67, v63, v67
    v_mul_f32 v72, v58, v64
    v_mul_f32 v73, -v58, v68
    v_fma_f32 v72, -v59, v68, v72
    v_fma_f32 v73, -v59, v64, v73
    v_cvt_pk_bf16_f32 v110, v65, v69
    v_cvt_pk_bf16_f32 v114, v66, v70
    v_cvt_pk_bf16_f32 v118, v67, v71
    v_cvt_pk_bf16_f32 v90, v72, v73
    v_lshlrev_b32 v60, 16, v110
    v_and_b32 v52, s30, v110
    v_lshlrev_b32 v61, 16, v114
    v_and_b32 v53, s30, v114
    v_lshlrev_b32 v62, 16, v118
    v_and_b32 v54, s30, v118
    v_lshlrev_b32 v63, 16, v90
    v_and_b32 v55, s30, v90
    v_sub_f32 v60, v65, v60
    v_sub_f32 v52, v69, v52
    v_sub_f32 v61, v66, v61
    v_sub_f32 v53, v70, v53
    v_sub_f32 v62, v67, v62
    v_sub_f32 v54, v71, v54
    v_sub_f32 v63, v72, v63
    v_sub_f32 v55, v73, v55
    v_cvt_pk_bf16_f32 v122, v60, v52
    v_cvt_pk_bf16_f32 v126, v61, v53
    v_cvt_pk_bf16_f32 v130, v62, v54
    v_cvt_pk_bf16_f32 v94, v63, v55
    v_and_b32 v52, s30, v9
    v_and_b32 v53, s30, v13
    v_and_b32 v54, s30, v17
    v_and_b32 v55, s30, v21
    v_and_b32 v56, s30, v25
    v_and_b32 v57, s30, v29
    v_mul_f32 v52, v45, v52
    v_mul_f32 v53, v46, v53
    v_mul_f32 v54, v7, v54
    v_mul_f32 v55, v7, v55
    v_mul_f32 v60, v40, v52
    v_mul_f32 v64, v40, v53
    v_mul_f32 v61, v41, v52
    v_mul_f32 v65, v41, v53
    v_mul_f32 v62, v42, v52
    v_mul_f32 v66, v42, v53
    v_mul_f32 v63, v43, v52
    v_mul_f32 v67, v43, v53
    v_exp_f32 v60, v60
    v_fract_f32 v64, v64
    v_exp_f32 v61, v61
    v_fract_f32 v65, v65
    v_exp_f32 v62, v62
    v_fract_f32 v66, v66
    v_exp_f32 v63, v63
    v_fract_f32 v67, v67
    v_sin_f32 v68, v64
    v_cos_f32 v64, v64
    v_mul_f32 v58, v56, v54
    v_sin_f32 v69, v65
    v_cos_f32 v65, v65
    v_mul_f32 v59, v56, v55
    v_sin_f32 v70, v66
    v_cos_f32 v66, v66
    v_fma_f32 v58, -v57, v55, v58
    v_sin_f32 v71, v67
    v_cos_f32 v67, v67
    v_fmac_f32 v59, v57, v54
    v_mul_f32 v68, v60, v68
    v_mul_f32 v64, v60, v64
    v_mul_f32 v69, v61, v69
    v_mul_f32 v65, v61, v65
    v_mul_f32 v70, v62, v70
    v_mul_f32 v66, v62, v66
    v_mul_f32 v71, v63, v71
    v_mul_f32 v67, v63, v67
    v_mul_f32 v72, v58, v64
    v_mul_f32 v73, -v58, v68
    v_fma_f32 v72, -v59, v68, v72
    v_fma_f32 v73, -v59, v64, v73
    v_cvt_pk_bf16_f32 v111, v65, v69
    v_cvt_pk_bf16_f32 v115, v66, v70
    v_cvt_pk_bf16_f32 v119, v67, v71
    v_cvt_pk_bf16_f32 v91, v72, v73
    v_lshlrev_b32 v60, 16, v111
    v_and_b32 v52, s30, v111
    v_lshlrev_b32 v61, 16, v115
    v_and_b32 v53, s30, v115
    v_lshlrev_b32 v62, 16, v119
    v_and_b32 v54, s30, v119
    v_lshlrev_b32 v63, 16, v91
    v_and_b32 v55, s30, v91
    v_sub_f32 v60, v65, v60
    v_sub_f32 v52, v69, v52
    v_sub_f32 v61, v66, v61
    v_sub_f32 v53, v70, v53
    v_sub_f32 v62, v67, v62
    v_sub_f32 v54, v71, v54
    v_sub_f32 v63, v72, v63
    v_sub_f32 v55, v73, v55
    v_cvt_pk_bf16_f32 v123, v60, v52
    v_cvt_pk_bf16_f32 v127, v61, v53
    v_cvt_pk_bf16_f32 v131, v62, v54
    v_cvt_pk_bf16_f32 v95, v63, v55
    s_nop 1
    v_mfma_f32_16x16x32_bf16 v[76:79], v[108:111], v[88:91], v[76:79]
    v_mfma_f32_16x16x32_bf16 v[80:83], v[112:115], v[88:91], v[80:83]
    v_mfma_f32_16x16x32_bf16 v[84:87], v[116:119], v[88:91], v[84:87]
    v_mfma_f32_16x16x32_bf16 v[76:79], v[108:111], v[92:95], v[76:79]
    v_mfma_f32_16x16x32_bf16 v[80:83], v[112:115], v[92:95], v[80:83]
    v_mfma_f32_16x16x32_bf16 v[84:87], v[116:119], v[92:95], v[84:87]
    v_mfma_f32_16x16x32_bf16 v[76:79], v[120:123], v[88:91], v[76:79]
    v_mfma_f32_16x16x32_bf16 v[80:83], v[124:127], v[88:91], v[80:83]
    v_mfma_f32_16x16x32_bf16 v[84:87], v[128:131], v[88:91], v[84:87]
    v_lshlrev_b32 v52, 16, v10
    v_lshlrev_b32 v53, 16, v14
    v_lshlrev_b32 v54, 16, v18
    v_lshlrev_b32 v55, 16, v22
    v_lshlrev_b32 v56, 16, v26
    v_lshlrev_b32 v57, 16, v30
    v_mul_f32 v52, v45, v52
    v_mul_f32 v53, v46, v53
    v_mul_f32 v54, v7, v54
    v_mul_f32 v55, v7, v55
    v_mul_f32 v60, v40, v52
    v_mul_f32 v64, v40, v53
    v_mul_f32 v61, v41, v52
    v_mul_f32 v65, v41, v53
    v_mul_f32 v62, v42, v52
    v_mul_f32 v66, v42, v53
    v_mul_f32 v63, v43, v52
    v_mul_f32 v67, v43, v53
    v_exp_f32 v60, v60
    v_fract_f32 v64, v64
    v_exp_f32 v61, v61
    v_fract_f32 v65, v65
    v_exp_f32 v62, v62
    v_fract_f32 v66, v66
    v_exp_f32 v63, v63
    v_fract_f32 v67, v67
    v_sin_f32 v68, v64
    v_cos_f32 v64, v64
    v_mul_f32 v58, v56, v54
    v_sin_f32 v69, v65
    v_cos_f32 v65, v65
    v_mul_f32 v59, v56, v55
    v_sin_f32 v70, v66
    v_cos_f32 v66, v66
    v_fma_f32 v58, -v57, v55, v58
    v_sin_f32 v71, v67
    v_cos_f32 v67, v67
    v_fmac_f32 v59, v57, v54
    v_mul_f32 v68, v60, v68
    v_mul_f32 v64, v60, v64
    v_mul_f32 v69, v61, v69
    v_mul_f32 v65, v61, v65
    v_mul_f32 v70, v62, v70
    v_mul_f32 v66, v62, v66
    v_mul_f32 v71, v63, v71
    v_mul_f32 v67, v63, v67
    v_mul_f32 v72, v58, v64
    v_mul_f32 v73, -v58, v68
    v_fma_f32 v72, -v59, v68, v72
    v_fma_f32 v73, -v59, v64, v73
    v_cvt_pk_bf16_f32 v108, v65, v69
    v_cvt_pk_bf16_f32 v112, v66, v70
    v_cvt_pk_bf16_f32 v116, v67, v71
    v_cvt_pk_bf16_f32 v88, v72, v73
    v_lshlrev_b32 v60, 16, v108
    v_and_b32 v52, s30, v108
    v_lshlrev_b32 v61, 16, v112
    v_and_b32 v53, s30, v112
    v_lshlrev_b32 v62, 16, v116
    v_and_b32 v54, s30, v116
    v_lshlrev_b32 v63, 16, v88
    v_and_b32 v55, s30, v88
    v_sub_f32 v60, v65, v60
    v_sub_f32 v52, v69, v52
    v_sub_f32 v61, v66, v61
    v_sub_f32 v53, v70, v53
    v_sub_f32 v62, v67, v62
    v_sub_f32 v54, v71, v54
    v_sub_f32 v63, v72, v63
    v_sub_f32 v55, v73, v55
    v_cvt_pk_bf16_f32 v120, v60, v52
    v_cvt_pk_bf16_f32 v124, v61, v53
    v_cvt_pk_bf16_f32 v128, v62, v54
    v_cvt_pk_bf16_f32 v92, v63, v55
    v_and_b32 v52, s30, v10
    v_and_b32 v53, s30, v14
    v_and_b32 v54, s30, v18
    v_and_b32 v55, s30, v22
    v_and_b32 v56, s30, v26
    v_and_b32 v57, s30, v30
    v_mul_f32 v52, v45, v52
    v_mul_f32 v53, v46, v53
    v_mul_f32 v54, v7, v54
    v_mul_f32 v55, v7, v55
    v_mul_f32 v60, v40, v52
    v_mul_f32 v64, v40, v53
    v_mul_f32 v61, v41, v52
    v_mul_f32 v65, v41, v53
    v_mul_f32 v62, v42, v52
    v_mul_f32 v66, v42, v53
    v_mul_f32 v63, v43, v52
    v_mul_f32 v67, v43, v53
    v_exp_f32 v60, v60
    v_fract_f32 v64, v64
    v_exp_f32 v61, v61
    v_fract_f32 v65, v65
    v_exp_f32 v62, v62
    v_fract_f32 v66, v66
    v_exp_f32 v63, v63
    v_fract_f32 v67, v67
    v_sin_f32 v68, v64
    v_cos_f32 v64, v64
    v_mul_f32 v58, v56, v54
    v_sin_f32 v69, v65
    v_cos_f32 v65, v65
    v_mul_f32 v59, v56, v55
    v_sin_f32 v70, v66
    v_cos_f32 v66, v66
    v_fma_f32 v58, -v57, v55, v58
    v_sin_f32 v71, v67
    v_cos_f32 v67, v67
    v_fmac_f32 v59, v57, v54
    v_mul_f32 v68, v60, v68
    v_mul_f32 v64, v60, v64
    v_mul_f32 v69, v61, v69
    v_mul_f32 v65, v61, v65
    v_mul_f32 v70, v62, v70
    v_mul_f32 v66, v62, v66
    v_mul_f32 v71, v63, v71
    v_mul_f32 v67, v63, v67
    v_mul_f32 v72, v58, v64
    v_mul_f32 v73, -v58, v68
    v_fma_f32 v72, -v59, v68, v72
    v_fma_f32 v73, -v59, v64, v73
    v_cvt_pk_bf16_f32 v109, v65, v69
    v_cvt_pk_bf16_f32 v113, v66, v70
    v_cvt_pk_bf16_f32 v117, v67, v71
    v_cvt_pk_bf16_f32 v89, v72, v73
    v_lshlrev_b32 v60, 16, v109
    v_and_b32 v52, s30, v109
    v_lshlrev_b32 v61, 16, v113
    v_and_b32 v53, s30, v113
    v_lshlrev_b32 v62, 16, v117
    v_and_b32 v54, s30, v117
    v_lshlrev_b32 v63, 16, v89
    v_and_b32 v55, s30, v89
    v_sub_f32 v60, v65, v60
    v_sub_f32 v52, v69, v52
    v_sub_f32 v61, v66, v61
    v_sub_f32 v53, v70, v53
    v_sub_f32 v62, v67, v62
    v_sub_f32 v54, v71, v54
    v_sub_f32 v63, v72, v63
    v_sub_f32 v55, v73, v55
    v_cvt_pk_bf16_f32 v121, v60, v52
    v_cvt_pk_bf16_f32 v125, v61, v53
    v_cvt_pk_bf16_f32 v129, v62, v54
    v_cvt_pk_bf16_f32 v93, v63, v55
    v_lshlrev_b32 v52, 16, v11
    v_lshlrev_b32 v53, 16, v15
    v_lshlrev_b32 v54, 16, v19
    v_lshlrev_b32 v55, 16, v23
    v_lshlrev_b32 v56, 16, v27
    v_lshlrev_b32 v57, 16, v31
    v_mul_f32 v52, v45, v52
    v_mul_f32 v53, v46, v53
    v_mul_f32 v54, v7, v54
    v_mul_f32 v55, v7, v55
    v_mul_f32 v60, v40, v52
    v_mul_f32 v64, v40, v53
    v_mul_f32 v61, v41, v52
    v_mul_f32 v65, v41, v53
    v_mul_f32 v62, v42, v52
    v_mul_f32 v66, v42, v53
    v_mul_f32 v63, v43, v52
    v_mul_f32 v67, v43, v53
    v_exp_f32 v60, v60
    v_fract_f32 v64, v64
    v_exp_f32 v61, v61
    v_fract_f32 v65, v65
    v_exp_f32 v62, v62
    v_fract_f32 v66, v66
    v_exp_f32 v63, v63
    v_fract_f32 v67, v67
    v_sin_f32 v68, v64
    v_cos_f32 v64, v64
    v_mul_f32 v58, v56, v54
    v_sin_f32 v69, v65
    v_cos_f32 v65, v65
    v_mul_f32 v59, v56, v55
    v_sin_f32 v70, v66
    v_cos_f32 v66, v66
    v_fma_f32 v58, -v57, v55, v58
    v_sin_f32 v71, v67
    v_cos_f32 v67, v67
    v_fmac_f32 v59, v57, v54
    v_mul_f32 v68, v60, v68
    v_mul_f32 v64, v60, v64
    v_mul_f32 v69, v61, v69
    v_mul_f32 v65, v61, v65
    v_mul_f32 v70, v62, v70
    v_mul_f32 v66, v62, v66
    v_mul_f32 v71, v63, v71
    v_mul_f32 v67, v63, v67
    v_mul_f32 v72, v58, v64
    v_mul_f32 v73, -v58, v68
    v_fma_f32 v72, -v59, v68, v72
    v_fma_f32 v73, -v59, v64, v73
    v_cvt_pk_bf16_f32 v110, v65, v69
    v_cvt_pk_bf16_f32 v114, v66, v70
    v_cvt_pk_bf16_f32 v118, v67, v71
    v_cvt_pk_bf16_f32 v90, v72, v73
    v_lshlrev_b32 v60, 16, v110
    v_and_b32 v52, s30, v110
    v_lshlrev_b32 v61, 16, v114
    v_and_b32 v53, s30, v114
    v_lshlrev_b32 v62, 16, v118
    v_and_b32 v54, s30, v118
    v_lshlrev_b32 v63, 16, v90
    v_and_b32 v55, s30, v90
    v_sub_f32 v60, v65, v60
    v_sub_f32 v52, v69, v52
    v_sub_f32 v61, v66, v61
    v_sub_f32 v53, v70, v53
    v_sub_f32 v62, v67, v62
    v_sub_f32 v54, v71, v54
    v_sub_f32 v63, v72, v63
    v_sub_f32 v55, v73, v55
    v_cvt_pk_bf16_f32 v122, v60, v52
    v_cvt_pk_bf16_f32 v126, v61, v53
    v_cvt_pk_bf16_f32 v130, v62, v54
    v_cvt_pk_bf16_f32 v94, v63, v55
    v_and_b32 v52, s30, v11
    v_and_b32 v53, s30, v15
    v_and_b32 v54, s30, v19
    v_and_b32 v55, s30, v23
    v_and_b32 v56, s30, v27
    v_and_b32 v57, s30, v31
    v_mul_f32 v52, v45, v52
    v_mul_f32 v53, v46, v53
    v_mul_f32 v54, v7, v54
    v_mul_f32 v55, v7, v55
    v_mul_f32 v60, v40, v52
    v_mul_f32 v64, v40, v53
    v_mul_f32 v61, v41, v52
    v_mul_f32 v65, v41, v53
    v_mul_f32 v62, v42, v52
    v_mul_f32 v66, v42, v53
    v_mul_f32 v63, v43, v52
    v_mul_f32 v67, v43, v53
    v_exp_f32 v60, v60
    v_fract_f32 v64, v64
    v_exp_f32 v61, v61
    v_fract_f32 v65, v65
    v_exp_f32 v62, v62
    v_fract_f32 v66, v66
    v_exp_f32 v63, v63
    v_fract_f32 v67, v67
    v_sin_f32 v68, v64
    v_cos_f32 v64, v64
    v_mul_f32 v58, v56, v54
    v_sin_f32 v69, v65
    v_cos_f32 v65, v65
    v_mul_f32 v59, v56, v55
    v_sin_f32 v70, v66
    v_cos_f32 v66, v66
    v_fma_f32 v58, -v57, v55, v58
    v_sin_f32 v71, v67
    v_cos_f32 v67, v67
    v_fmac_f32 v59, v57, v54
    v_mul_f32 v68, v60, v68
    v_mul_f32 v64, v60, v64
    v_mul_f32 v69, v61, v69
    v_mul_f32 v65, v61, v65
    v_mul_f32 v70, v62, v70
    v_mul_f32 v66, v62, v66
    v_mul_f32 v71, v63, v71
    v_mul_f32 v67, v63, v67
    v_mul_f32 v72, v58, v64
    v_mul_f32 v73, -v58, v68
    v_fma_f32 v72, -v59, v68, v72
    v_fma_f32 v73, -v59, v64, v73
    v_cvt_pk_bf16_f32 v111, v65, v69
    v_cvt_pk_bf16_f32 v115, v66, v70
    v_cvt_pk_bf16_f32 v119, v67, v71
    v_cvt_pk_bf16_f32 v91, v72, v73
    v_lshlrev_b32 v60, 16, v111
    v_and_b32 v52, s30, v111
    v_lshlrev_b32 v61, 16, v115
    v_and_b32 v53, s30, v115
    v_lshlrev_b32 v62, 16, v119
    v_and_b32 v54, s30, v119
    v_lshlrev_b32 v63, 16, v91
    v_and_b32 v55, s30, v91
    v_sub_f32 v60, v65, v60
    v_sub_f32 v52, v69, v52
    v_sub_f32 v61, v66, v61
    v_sub_f32 v53, v70, v53
    v_sub_f32 v62, v67, v62
    v_sub_f32 v54, v71, v54
    v_sub_f32 v63, v72, v63
    v_sub_f32 v55, v73, v55
    v_cvt_pk_bf16_f32 v123, v60, v52
    v_cvt_pk_bf16_f32 v127, v61, v53
    v_cvt_pk_bf16_f32 v131, v62, v54
    v_cvt_pk_bf16_f32 v95, v63, v55
    s_nop 1
    v_mfma_f32_16x16x32_bf16 v[76:79], v[108:111], v[88:91], v[76:79]
    v_mfma_f32_16x16x32_bf16 v[80:83], v[112:115], v[88:91], v[80:83]
    v_mfma_f32_16x16x32_bf16 v[84:87], v[116:119], v[88:91], v[84:87]
    v_mfma_f32_16x16x32_bf16 v[76:79], v[108:111], v[92:95], v[76:79]
    v_mfma_f32_16x16x32_bf16 v[80:83], v[112:115], v[92:95], v[80:83]
    v_mfma_f32_16x16x32_bf16 v[84:87], v[116:119], v[92:95], v[84:87]
    v_mfma_f32_16x16x32_bf16 v[76:79], v[120:123], v[88:91], v[76:79]
    v_mfma_f32_16x16x32_bf16 v[80:83], v[124:127], v[88:91], v[80:83]
    v_mfma_f32_16x16x32_bf16 v[84:87], v[128:131], v[88:91], v[84:87]
    buffer_load_dwordx4 v[104:107], v6, s[40:43], s35 offen
    s_add_u32 s35, s35, 4096
    buffer_load_dwordx4 v[104:107], v6, s[40:43], s35 offen
    s_add_u32 s35, s35, 4096
    buffer_load_dwordx4 v[104:107], v6, s[40:43], s35 offen
    s_add_u32 s35, s35, 4096
    buffer_load_dwordx4 v[104:107], v6, s[40:43], s35 offen
    s_add_u32 s35, s35, 4096
    v_mul_u32_u24 v4, 3072, v3
    v_lshl_add_u32 v4, v2, 8, v4
    v_lshl_add_u32 v4, v1, 2, v4
    s_mul_i32 s5, s3, 3072
    s_add_u32 s5, s5, 4259840
    v_lshlrev_b32 v5, 4, v0
    s_nop 7
    ds_write_b32 v4, v76 offset:0
    ds_write_b32 v4, v77 offset:64
    ds_write_b32 v4, v78 offset:128
    ds_write_b32 v4, v79 offset:192
    ds_write_b32 v4, v80 offset:1024
    ds_write_b32 v4, v81 offset:1088
    ds_write_b32 v4, v82 offset:1152
    ds_write_b32 v4, v83 offset:1216
    ds_write_b32 v4, v84 offset:2048
    ds_write_b32 v4, v85 offset:2112
    ds_write_b32 v4, v86 offset:2176
    ds_write_b32 v4, v87 offset:2240
    s_waitcnt lgkmcnt(0)
    s_barrier
    v_cmp_gt_u32 vcc, 192, v0
    s_and_saveexec_b64 s[26:27], vcc
    s_cbranch_execz k1_exp_end
    ds_read_b128 v[8:11], v5 offset:0
    ds_read_b128 v[12:15], v5 offset:3072
    ds_read_b128 v[16:19], v5 offset:6144
    ds_read_b128 v[20:23], v5 offset:9216
    s_waitcnt lgkmcnt(0)
    v_add_f32 v8, v8, v12
    v_add_f32 v16, v16, v20
    v_add_f32 v8, v8, v16
    v_add_f32 v9, v9, v13
    v_add_f32 v17, v17, v21
    v_add_f32 v9, v9, v17
    v_add_f32 v10, v10, v14
    v_add_f32 v18, v18, v22
    v_add_f32 v10, v10, v18
    v_add_f32 v11, v11, v15
    v_add_f32 v19, v19, v23
    v_add_f32 v11, v11, v19
    buffer_store_dwordx4 v[8:11], v5, s[20:23], s5 offen sc1
k1_exp_end:
k1_done:
    s_endpgm
.p2align 8
k2_kernel:
    s_cmp_ge_u32 s2, 480
    s_cbranch_scc1 k2_done
    s_load_dwordx2 s[8:9], s[0:1], 136
    s_cmp_lt_u32 s2, 256
    s_cbranch_scc1 k2_conv
    s_sub_u32 s56, s2, 256
    s_setprio 2
    s_load_dwordx4 s[4:7], s[0:1], 80
    s_and_b32 s3, s56, 7
    s_lshr_b32 s10, s56, 3
    s_and_b32 s11, s3, 1
    s_lshl_b32 s11, s11, 2
    s_and_b32 s54, s10, 3
    s_add_u32 s54, s54, s11
    s_lshr_b32 s11, s3, 1
    s_mul_i32 s11, s11, 7
    s_lshr_b32 s55, s10, 2
    s_add_u32 s55, s55, s11
    s_lshl_b32 s48, s54, 18
    s_add_u32 s48, s48, 0
    s_lshl_b32 s49, s55, 7
    v_and_b32 v1, 63, v0
    v_lshrrev_b32 v2, 6, v0
    s_nop 0
    v_readfirstlane_b32 s40, v2
    v_lshlrev_b32 v3, 4, v1
    v_lshrrev_b32 v4, 3, v1
    v_and_b32 v5, 7, v1
    v_lshlrev_b32 v6, 1, v4
    v_and_b32 v6, 4, v6
    v_xor_b32 v5, v5, v6
    s_mov_b32 s41, 3584
    v_mul_lo_u32 v4, v4, s41
    v_lshl_add_u32 v4, v5, 4, v4
    v_add_u32 v5, 27648, v4
    s_mul_i32 s42, s40, 16384
    s_mul_i32 s43, s40, 65536
    s_add_u32 s43, s43, s48
    s_mul_i32 s44, s40, 1835008
    s_add_u32 s44, s44, s49
    s_waitcnt lgkmcnt(0)
    s_mov_b32 s12, s4
    s_and_b32 s13, s5, 0xffff
    s_mov_b32 s14, 7340032
    s_mov_b32 s15, 0x00020000
    s_mov_b32 s16, s6
    s_and_b32 s17, s7, 0xffff
    s_mov_b32 s18, 3584
    s_mov_b32 s19, 0x00020000
    s_mov_b32 s20, s8
    s_and_b32 s21, s9, 0xffff
    s_mov_b32 s22, 12910592
    s_mov_b32 s23, 0x00020000
    s_add_u32 s45, s42, 0
    s_mov_b32 m0, s45
    s_add_u32 s45, s42, 2048
    buffer_load_dwordx4 v3, s[20:23], s43 offen lds
    buffer_load_dwordx4 v3, s[20:23], s43 offen offset:1024 lds
    s_mov_b32 m0, s45
    s_add_u32 s43, s43, 2048
    buffer_load_dwordx4 v4, s[12:15], s44 offen lds
    buffer_load_dwordx4 v5, s[12:15], s44 offen offset:1024 lds
    s_add_u32 s44, s44, 57344
    s_add_u32 s45, s42, 4096
    s_mov_b32 m0, s45
    s_add_u32 s45, s42, 6144
    buffer_load_dwordx4 v3, s[20:23], s43 offen lds
    buffer_load_dwordx4 v3, s[20:23], s43 offen offset:1024 lds
    s_mov_b32 m0, s45
    s_add_u32 s43, s43, 2048
    buffer_load_dwordx4 v4, s[12:15], s44 offen lds
    buffer_load_dwordx4 v5, s[12:15], s44 offen offset:1024 lds
    s_add_u32 s44, s44, 57344
    s_add_u32 s45, s42, 8192
    s_mov_b32 m0, s45
    s_add_u32 s45, s42, 10240
    buffer_load_dwordx4 v3, s[20:23], s43 offen lds
    buffer_load_dwordx4 v3, s[20:23], s43 offen offset:1024 lds
    s_mov_b32 m0, s45
    s_add_u32 s43, s43, 2048
    buffer_load_dwordx4 v4, s[12:15], s44 offen lds
    buffer_load_dwordx4 v5, s[12:15], s44 offen offset:1024 lds
    s_add_u32 s44, s44, 57344
    s_and_b32 s45, s40, 1
    s_lshl_b32 s45, s45, 6
    s_add_u32 s45, s45, s49
    v_lshrrev_b32 v12, 5, v1
    v_lshlrev_b32 v12, 3, v12
    buffer_load_dwordx2 v[48:49], v12, s[16:19], s45 offen offset:0
    buffer_load_dwordx2 v[50:51], v12, s[16:19], s45 offen offset:16
    buffer_load_dwordx2 v[52:53], v12, s[16:19], s45 offen offset:32
    buffer_load_dwordx2 v[54:55], v12, s[16:19], s45 offen offset:48
    s_lshr_b32 s46, s40, 1
    s_and_b32 s47, s40, 1
    v_and_b32 v6, 31, v1
    v_lshrrev_b32 v7, 5, v1
    v_lshlrev_b32 v6, 4, v6
    v_lshl_add_u32 v6, v7, 10, v6
    s_lshl_b32 s45, s46, 9
    s_add_u32 s45, s45, s42
    v_add_u32 v6, s45, v6
    v_xor_b32 v8, 512, v6
    v_bfe_u32 v11, v1, 2, 2
    v_lshl_add_u32 v9, v7, 3, v11
    v_lshlrev_b32 v9, 7, v9
    v_lshrrev_b32 v10, 1, v11
    v_lshl_add_u32 v9, v10, 6, v9
    v_bfe_u32 v10, v1, 4, 1
    v_lshl_add_u32 v9, v10, 5, v9
    v_bfe_u32 v10, v1, 1, 1
    v_lshl_add_u32 v9, v10, 4, v9
    v_and_b32 v10, 1, v1
    v_lshl_add_u32 v9, v10, 3, v9
    s_lshl_b32 s45, s47, 6
    v_xor_b32 v9, s45, v9
    s_add_u32 s45, s42, 2048
    v_add_u32 v9, s45, v9
    v_xor_b32 v10, 64, v9
    v_mov_b32 v64, 0
    v_mov_b32 v65, 0
    v_mov_b32 v66, 0
    v_mov_b32 v67, 0
    v_mov_b32 v68, 0
    v_mov_b32 v69, 0
    v_mov_b32 v70, 0
    v_mov_b32 v71, 0
    v_mov_b32 v72, 0
    v_mov_b32 v73, 0
    v_mov_b32 v74, 0
    v_mov_b32 v75, 0
    v_mov_b32 v76, 0
    v_mov_b32 v77, 0
    v_mov_b32 v78, 0
    v_mov_b32 v79, 0
    v_mov_b32 v80, 0
    v_mov_b32 v81, 0
    v_mov_b32 v82, 0
    v_mov_b32 v83, 0
    v_mov_b32 v84, 0
    v_mov_b32 v85, 0
    v_mov_b32 v86, 0
    v_mov_b32 v87, 0
    v_mov_b32 v88, 0
    v_mov_b32 v89, 0
    v_mov_b32 v90, 0
    v_mov_b32 v91, 0
    v_mov_b32 v92, 0
    v_mov_b32 v93, 0
    v_mov_b32 v94, 0
    v_mov_b32 v95, 0
    v_mov_b32 v96, 0
    v_mov_b32 v97, 0
    v_mov_b32 v98, 0
    v_mov_b32 v99, 0
    v_mov_b32 v100, 0
    v_mov_b32 v101, 0
    v_mov_b32 v102, 0
    v_mov_b32 v103, 0
    v_mov_b32 v104, 0
    v_mov_b32 v105, 0
    v_mov_b32 v106, 0
    v_mov_b32 v107, 0
    v_mov_b32 v108, 0
    v_mov_b32 v109, 0
    v_mov_b32 v110, 0
    v_mov_b32 v111, 0
    v_mov_b32 v112, 0
    v_mov_b32 v113, 0
    v_mov_b32 v114, 0
    v_mov_b32 v115, 0
    v_mov_b32 v116, 0
    v_mov_b32 v117, 0
    v_mov_b32 v118, 0
    v_mov_b32 v119, 0
    v_mov_b32 v120, 0
    v_mov_b32 v121, 0
    v_mov_b32 v122, 0
    v_mov_b32 v123, 0
    v_mov_b32 v124, 0
    v_mov_b32 v125, 0
    v_mov_b32 v126, 0
    v_mov_b32 v127, 0
    s_waitcnt vmcnt(12)
    ds_read_b128 v[16:19], v6 offset:0
    ds_read_b128 v[20:23], v8 offset:0
    ds_read_b64_tr_b16 v[24:25], v9 offset:0
    ds_read_b64_tr_b16 v[26:27], v9 offset:512
    ds_read_b64_tr_b16 v[28:29], v10 offset:0
    ds_read_b64_tr_b16 v[30:31], v10 offset:512
    s_add_u32 s45, s42, 12288
    s_mov_b32 m0, s45
    s_add_u32 s45, s42, 14336
    buffer_load_dwordx4 v3, s[20:23], s43 offen lds
    buffer_load_dwordx4 v3, s[20:23], s43 offen offset:1024 lds
    s_mov_b32 m0, s45
    s_add_u32 s43, s43, 2048
    buffer_load_dwordx4 v4, s[12:15], s44 offen lds
    buffer_load_dwordx4 v5, s[12:15], s44 offen offset:1024 lds
    s_add_u32 s44, s44, 57344
    s_waitcnt vmcnt(12)
    ds_read_b128 v[32:35], v6 offset:4096
    ds_read_b128 v[36:39], v8 offset:4096
    ds_read_b64_tr_b16 v[40:41], v9 offset:4096
    ds_read_b64_tr_b16 v[42:43], v9 offset:4608
    ds_read_b64_tr_b16 v[44:45], v10 offset:4096
    ds_read_b64_tr_b16 v[46:47], v10 offset:4608
    s_waitcnt lgkmcnt(6)
    v_mfma_f32_32x32x16_bf16 v[64:79], v[24:27], v[16:19], v[64:79]
    v_mfma_f32_32x32x16_bf16 v[80:95], v[28:31], v[16:19], v[80:95]
    v_mfma_f32_32x32x16_bf16 v[96:111], v[24:27], v[20:23], v[96:111]
    v_mfma_f32_32x32x16_bf16 v[112:127], v[28:31], v[20:23], v[112:127]
    s_add_u32 s45, s42, 0
    s_mov_b32 m0, s45
    s_add_u32 s45, s42, 2048
    buffer_load_dwordx4 v3, s[20:23], s43 offen lds
    buffer_load_dwordx4 v3, s[20:23], s43 offen offset:1024 lds
    s_mov_b32 m0, s45
    s_add_u32 s43, s43, 2048
    buffer_load_dwordx4 v4, s[12:15], s44 offen lds
    buffer_load_dwordx4 v5, s[12:15], s44 offen offset:1024 lds
    s_add_u32 s44, s44, 57344
    s_waitcnt vmcnt(12)
    ds_read_b128 v[16:19], v6 offset:8192
    ds_read_b128 v[20:23], v8 offset:8192
    ds_read_b64_tr_b16 v[24:25], v9 offset:8192
    ds_read_b64_tr_b16 v[26:27], v9 offset:8704
    ds_read_b64_tr_b16 v[28:29], v10 offset:8192
    ds_read_b64_tr_b16 v[30:31], v10 offset:8704
    s_waitcnt lgkmcnt(6)
    v_mfma_f32_32x32x16_bf16 v[64:79], v[40:43], v[32:35], v[64:79]
    v_mfma_f32_32x32x16_bf16 v[80:95], v[44:47], v[32:35], v[80:95]
    v_mfma_f32_32x32x16_bf16 v[96:111], v[40:43], v[36:39], v[96:111]
    v_mfma_f32_32x32x16_bf16 v[112:127], v[44:47], v[36:39], v[112:127]
    s_add_u32 s45, s42, 4096
    s_mov_b32 m0, s45
    s_add_u32 s45, s42, 6144
    buffer_load_dwordx4 v3, s[20:23], s43 offen lds
    buffer_load_dwordx4 v3, s[20:23], s43 offen offset:1024 lds
    s_mov_b32 m0, s45
    s_add_u32 s43, s43, 2048
    buffer_load_dwordx4 v4, s[12:15], s44 offen lds
    buffer_load_dwordx4 v5, s[12:15], s44 offen offset:1024 lds
    s_add_u32 s44, s44, 57344
    s_waitcnt vmcnt(8)
    ds_read_b128 v[32:35], v6 offset:12288
    ds_read_b128 v[36:39], v8 offset:12288
    ds_read_b64_tr_b16 v[40:41], v9 offset:12288
    ds_read_b64_tr_b16 v[42:43], v9 offset:12800
    ds_read_b64_tr_b16 v[44:45], v10 offset:12288
    ds_read_b64_tr_b16 v[46:47], v10 offset:12800
    s_waitcnt lgkmcnt(6)
    v_mfma_f32_32x32x16_bf16 v[64:79], v[24:27], v[16:19], v[64:79]
    v_mfma_f32_32x32x16_bf16 v[80:95], v[28:31], v[16:19], v[80:95]
    v_mfma_f32_32x32x16_bf16 v[96:111], v[24:27], v[20:23], v[96:111]
    v_mfma_f32_32x32x16_bf16 v[112:127], v[28:31], v[20:23], v[112:127]
    s_add_u32 s45, s42, 8192
    s_mov_b32 m0, s45
    s_add_u32 s45, s42, 10240
    buffer_load_dwordx4 v3, s[20:23], s43 offen lds
    buffer_load_dwordx4 v3, s[20:23], s43 offen offset:1024 lds
    s_mov_b32 m0, s45
    s_add_u32 s43, s43, 2048
    buffer_load_dwordx4 v4, s[12:15], s44 offen lds
    buffer_load_dwordx4 v5, s[12:15], s44 offen offset:1024 lds
    s_add_u32 s44, s44, 57344
    s_waitcnt vmcnt(8)
    ds_read_b128 v[16:19], v6 offset:0
    ds_read_b128 v[20:23], v8 offset:0
    ds_read_b64_tr_b16 v[24:25], v9 offset:0
    ds_read_b64_tr_b16 v[26:27], v9 offset:512
    ds_read_b64_tr_b16 v[28:29], v10 offset:0
    ds_read_b64_tr_b16 v[30:31], v10 offset:512
    s_waitcnt lgkmcnt(6)
    v_mfma_f32_32x32x16_bf16 v[64:79], v[40:43], v[32:35], v[64:79]
    v_mfma_f32_32x32x16_bf16 v[80:95], v[44:47], v[32:35], v[80:95]
    v_mfma_f32_32x32x16_bf16 v[96:111], v[40:43], v[36:39], v[96:111]
    v_mfma_f32_32x32x16_bf16 v[112:127], v[44:47], v[36:39], v[112:127]
    s_add_u32 s45, s42, 12288
    s_mov_b32 m0, s45
    s_add_u32 s45, s42, 14336
    buffer_load_dwordx4 v3, s[20:23], s43 offen lds
    buffer_load_dwordx4 v3, s[20:23], s43 offen offset:1024 lds
    s_mov_b32 m0, s45
    s_add_u32 s43, s43, 2048
    buffer_load_dwordx4 v4, s[12:15], s44 offen lds
    buffer_load_dwordx4 v5, s[12:15], s44 offen offset:1024 lds
    s_add_u32 s44, s44, 57344
    s_waitcnt vmcnt(8)
    ds_read_b128 v[32:35], v6 offset:4096
    ds_read_b128 v[36:39], v8 offset:4096
    ds_read_b64_tr_b16 v[40:41], v9 offset:4096
    ds_read_b64_tr_b16 v[42:43], v9 offset:4608
    ds_read_b64_tr_b16 v[44:45], v10 offset:4096
    ds_read_b64_tr_b16 v[46:47], v10 offset:4608
    s_waitcnt lgkmcnt(6)
    v_mfma_f32_32x32x16_bf16 v[64:79], v[24:27], v[16:19], v[64:79]
    v_mfma_f32_32x32x16_bf16 v[80:95], v[28:31], v[16:19], v[80:95]
    v_mfma_f32_32x32x16_bf16 v[96:111], v[24:27], v[20:23], v[96:111]
    v_mfma_f32_32x32x16_bf16 v[112:127], v[28:31], v[20:23], v[112:127]
    s_add_u32 s45, s42, 0
    s_mov_b32 m0, s45
    s_add_u32 s45, s42, 2048
    buffer_load_dwordx4 v3, s[20:23], s43 offen lds
    buffer_load_dwordx4 v3, s[20:23], s43 offen offset:1024 lds
    s_mov_b32 m0, s45
    s_add_u32 s43, s43, 2048
    buffer_load_dwordx4 v4, s[12:15], s44 offen lds
    buffer_load_dwordx4 v5, s[12:15], s44 offen offset:1024 lds
    s_add_u32 s44, s44, 57344
    s_waitcnt vmcnt(8)
    ds_read_b128 v[16:19], v6 offset:8192
    ds_read_b128 v[20:23], v8 offset:8192
    ds_read_b64_tr_b16 v[24:25], v9 offset:8192
    ds_read_b64_tr_b16 v[26:27], v9 offset:8704
    ds_read_b64_tr_b16 v[28:29], v10 offset:8192
    ds_read_b64_tr_b16 v[30:31], v10 offset:8704
    s_waitcnt lgkmcnt(6)
    v_mfma_f32_32x32x16_bf16 v[64:79], v[40:43], v[32:35], v[64:79]
    v_mfma_f32_32x32x16_bf16 v[80:95], v[44:47], v[32:35], v[80:95]
    v_mfma_f32_32x32x16_bf16 v[96:111], v[40:43], v[36:39], v[96:111]
    v_mfma_f32_32x32x16_bf16 v[112:127], v[44:47], v[36:39], v[112:127]
    s_add_u32 s45, s42, 4096
    s_mov_b32 m0, s45
    s_add_u32 s45, s42, 6144
    buffer_load_dwordx4 v3, s[20:23], s43 offen lds
    buffer_load_dwordx4 v3, s[20:23], s43 offen offset:1024 lds
    s_mov_b32 m0, s45
    s_add_u32 s43, s43, 2048
    buffer_load_dwordx4 v4, s[12:15], s44 offen lds
    buffer_load_dwordx4 v5, s[12:15], s44 offen offset:1024 lds
    s_add_u32 s44, s44, 57344
    s_waitcnt vmcnt(8)
    ds_read_b128 v[32:35], v6 offset:12288
    ds_read_b128 v[36:39], v8 offset:12288
    ds_read_b64_tr_b16 v[40:41], v9 offset:12288
    ds_read_b64_tr_b16 v[42:43], v9 offset:12800
    ds_read_b64_tr_b16 v[44:45], v10 offset:12288
    ds_read_b64_tr_b16 v[46:47], v10 offset:12800
    s_waitcnt lgkmcnt(6)
    v_mfma_f32_32x32x16_bf16 v[64:79], v[24:27], v[16:19], v[64:79]
    v_mfma_f32_32x32x16_bf16 v[80:95], v[28:31], v[16:19], v[80:95]
    v_mfma_f32_32x32x16_bf16 v[96:111], v[24:27], v[20:23], v[96:111]
    v_mfma_f32_32x32x16_bf16 v[112:127], v[28:31], v[20:23], v[112:127]
    s_add_u32 s45, s42, 8192
    s_mov_b32 m0, s45
    s_add_u32 s45, s42, 10240
    buffer_load_dwordx4 v3, s[20:23], s43 offen lds
    buffer_load_dwordx4 v3, s[20:23], s43 offen offset:1024 lds
    s_mov_b32 m0, s45
    s_add_u32 s43, s43, 2048
    buffer_load_dwordx4 v4, s[12:15], s44 offen lds
    buffer_load_dwordx4 v5, s[12:15], s44 offen offset:1024 lds
    s_add_u32 s44, s44, 57344
    s_waitcnt vmcnt(8)
    ds_read_b128 v[16:19], v6 offset:0
    ds_read_b128 v[20:23], v8 offset:0
    ds_read_b64_tr_b16 v[24:25], v9 offset:0
    ds_read_b64_tr_b16 v[26:27], v9 offset:512
    ds_read_b64_tr_b16 v[28:29], v10 offset:0
    ds_read_b64_tr_b16 v[30:31], v10 offset:512
    s_waitcnt lgkmcnt(6)
    v_mfma_f32_32x32x16_bf16 v[64:79], v[40:43], v[32:35], v[64:79]
    v_mfma_f32_32x32x16_bf16 v[80:95], v[44:47], v[32:35], v[80:95]
    v_mfma_f32_32x32x16_bf16 v[96:111], v[40:43], v[36:39], v[96:111]
    v_mfma_f32_32x32x16_bf16 v[112:127], v[44:47], v[36:39], v[112:127]
    s_add_u32 s45, s42, 12288
    s_mov_b32 m0, s45
    s_add_u32 s45, s42, 14336
    buffer_load_dwordx4 v3, s[20:23], s43 offen lds
    buffer_load_dwordx4 v3, s[20:23], s43 offen offset:1024 lds
    s_mov_b32 m0, s45
    s_add_u32 s43, s43, 2048
    buffer_load_dwordx4 v4, s[12:15], s44 offen lds
    buffer_load_dwordx4 v5, s[12:15], s44 offen offset:1024 lds
    s_add_u32 s44, s44, 57344
    s_waitcnt vmcnt(8)
    ds_read_b128 v[32:35], v6 offset:4096
    ds_read_b128 v[36:39], v8 offset:4096
    ds_read_b64_tr_b16 v[40:41], v9 offset:4096
    ds_read_b64_tr_b16 v[42:43], v9 offset:4608
    ds_read_b64_tr_b16 v[44:45], v10 offset:4096
    ds_read_b64_tr_b16 v[46:47], v10 offset:4608
    s_waitcnt lgkmcnt(6)
    v_mfma_f32_32x32x16_bf16 v[64:79], v[24:27], v[16:19], v[64:79]
    v_mfma_f32_32x32x16_bf16 v[80:95], v[28:31], v[16:19], v[80:95]
    v_mfma_f32_32x32x16_bf16 v[96:111], v[24:27], v[20:23], v[96:111]
    v_mfma_f32_32x32x16_bf16 v[112:127], v[28:31], v[20:23], v[112:127]
    s_add_u32 s45, s42, 0
    s_mov_b32 m0, s45
    s_add_u32 s45, s42, 2048
    buffer_load_dwordx4 v3, s[20:23], s43 offen lds
    buffer_load_dwordx4 v3, s[20:23], s43 offen offset:1024 lds
    s_mov_b32 m0, s45
    s_add_u32 s43, s43, 2048
    buffer_load_dwordx4 v4, s[12:15], s44 offen lds
    buffer_load_dwordx4 v5, s[12:15], s44 offen offset:1024 lds
    s_add_u32 s44, s44, 57344
    s_waitcnt vmcnt(8)
    ds_read_b128 v[16:19], v6 offset:8192
    ds_read_b128 v[20:23], v8 offset:8192
    ds_read_b64_tr_b16 v[24:25], v9 offset:8192
    ds_read_b64_tr_b16 v[26:27], v9 offset:8704
    ds_read_b64_tr_b16 v[28:29], v10 offset:8192
    ds_read_b64_tr_b16 v[30:31], v10 offset:8704
    s_waitcnt lgkmcnt(6)
    v_mfma_f32_32x32x16_bf16 v[64:79], v[40:43], v[32:35], v[64:79]
    v_mfma_f32_32x32x16_bf16 v[80:95], v[44:47], v[32:35], v[80:95]
    v_mfma_f32_32x32x16_bf16 v[96:111], v[40:43], v[36:39], v[96:111]
    v_mfma_f32_32x32x16_bf16 v[112:127], v[44:47], v[36:39], v[112:127]
    s_add_u32 s45, s42, 4096
    s_mov_b32 m0, s45
    s_add_u32 s45, s42, 6144
    buffer_load_dwordx4 v3, s[20:23], s43 offen lds
    buffer_load_dwordx4 v3, s[20:23], s43 offen offset:1024 lds
    s_mov_b32 m0, s45
    s_add_u32 s43, s43, 2048
    buffer_load_dwordx4 v4, s[12:15], s44 offen lds
    buffer_load_dwordx4 v5, s[12:15], s44 offen offset:1024 lds
    s_add_u32 s44, s44, 57344
    s_waitcnt vmcnt(8)
    ds_read_b128 v[32:35], v6 offset:12288
    ds_read_b128 v[36:39], v8 offset:12288
    ds_read_b64_tr_b16 v[40:41], v9 offset:12288
    ds_read_b64_tr_b16 v[42:43], v9 offset:12800
    ds_read_b64_tr_b16 v[44:45], v10 offset:12288
    ds_read_b64_tr_b16 v[46:47], v10 offset:12800
    s_waitcnt lgkmcnt(6)
    v_mfma_f32_32x32x16_bf16 v[64:79], v[24:27], v[16:19], v[64:79]
    v_mfma_f32_32x32x16_bf16 v[80:95], v[28:31], v[16:19], v[80:95]
    v_mfma_f32_32x32x16_bf16 v[96:111], v[24:27], v[20:23], v[96:111]
    v_mfma_f32_32x32x16_bf16 v[112:127], v[28:31], v[20:23], v[112:127]
    s_add_u32 s45, s42, 8192
    s_mov_b32 m0, s45
    s_add_u32 s45, s42, 10240
    buffer_load_dwordx4 v3, s[20:23], s43 offen lds
    buffer_load_dwordx4 v3, s[20:23], s43 offen offset:1024 lds
    s_mov_b32 m0, s45
    s_add_u32 s43, s43, 2048
    buffer_load_dwordx4 v4, s[12:15], s44 offen lds
    buffer_load_dwordx4 v5, s[12:15], s44 offen offset:1024 lds
    s_add_u32 s44, s44, 57344
    s_waitcnt vmcnt(8)
    ds_read_b128 v[16:19], v6 offset:0
    ds_read_b128 v[20:23], v8 offset:0
    ds_read_b64_tr_b16 v[24:25], v9 offset:0
    ds_read_b64_tr_b16 v[26:27], v9 offset:512
    ds_read_b64_tr_b16 v[28:29], v10 offset:0
    ds_read_b64_tr_b16 v[30:31], v10 offset:512
    s_waitcnt lgkmcnt(6)
    v_mfma_f32_32x32x16_bf16 v[64:79], v[40:43], v[32:35], v[64:79]
    v_mfma_f32_32x32x16_bf16 v[80:95], v[44:47], v[32:35], v[80:95]
    v_mfma_f32_32x32x16_bf16 v[96:111], v[40:43], v[36:39], v[96:111]
    v_mfma_f32_32x32x16_bf16 v[112:127], v[44:47], v[36:39], v[112:127]
    s_add_u32 s45, s42, 12288
    s_mov_b32 m0, s45
    s_add_u32 s45, s42, 14336
    buffer_load_dwordx4 v3, s[20:23], s43 offen lds
    buffer_load_dwordx4 v3, s[20:23], s43 offen offset:1024 lds
    s_mov_b32 m0, s45
    s_add_u32 s43, s43, 2048
    buffer_load_dwordx4 v4, s[12:15], s44 offen lds
    buffer_load_dwordx4 v5, s[12:15], s44 offen offset:1024 lds
    s_add_u32 s44, s44, 57344
    s_waitcnt vmcnt(8)
    ds_read_b128 v[32:35], v6 offset:4096
    ds_read_b128 v[36:39], v8 offset:4096
    ds_read_b64_tr_b16 v[40:41], v9 offset:4096
    ds_read_b64_tr_b16 v[42:43], v9 offset:4608
    ds_read_b64_tr_b16 v[44:45], v10 offset:4096
    ds_read_b64_tr_b16 v[46:47], v10 offset:4608
    s_waitcnt lgkmcnt(6)
    v_mfma_f32_32x32x16_bf16 v[64:79], v[24:27], v[16:19], v[64:79]
    v_mfma_f32_32x32x16_bf16 v[80:95], v[28:31], v[16:19], v[80:95]
    v_mfma_f32_32x32x16_bf16 v[96:111], v[24:27], v[20:23], v[96:111]
    v_mfma_f32_32x32x16_bf16 v[112:127], v[28:31], v[20:23], v[112:127]
    s_add_u32 s45, s42, 0
    s_mov_b32 m0, s45
    s_add_u32 s45, s42, 2048
    buffer_load_dwordx4 v3, s[20:23], s43 offen lds
    buffer_load_dwordx4 v3, s[20:23], s43 offen offset:1024 lds
    s_mov_b32 m0, s45
    s_add_u32 s43, s43, 2048
    buffer_load_dwordx4 v4, s[12:15], s44 offen lds
    buffer_load_dwordx4 v5, s[12:15], s44 offen offset:1024 lds
    s_add_u32 s44, s44, 57344
    s_waitcnt vmcnt(8)
    ds_read_b128 v[16:19], v6 offset:8192
    ds_read_b128 v[20:23], v8 offset:8192
    ds_read_b64_tr_b16 v[24:25], v9 offset:8192
    ds_read_b64_tr_b16 v[26:27], v9 offset:8704
    ds_read_b64_tr_b16 v[28:29], v10 offset:8192
    ds_read_b64_tr_b16 v[30:31], v10 offset:8704
    s_waitcnt lgkmcnt(6)
    v_mfma_f32_32x32x16_bf16 v[64:79], v[40:43], v[32:35], v[64:79]
    v_mfma_f32_32x32x16_bf16 v[80:95], v[44:47], v[32:35], v[80:95]
    v_mfma_f32_32x32x16_bf16 v[96:111], v[40:43], v[36:39], v[96:111]
    v_mfma_f32_32x32x16_bf16 v[112:127], v[44:47], v[36:39], v[112:127]
    s_add_u32 s45, s42, 4096
    s_mov_b32 m0, s45
    s_add_u32 s45, s42, 6144
    buffer_load_dwordx4 v3, s[20:23], s43 offen lds
    buffer_load_dwordx4 v3, s[20:23], s43 offen offset:1024 lds
    s_mov_b32 m0, s45
    s_add_u32 s43, s43, 2048
    buffer_load_dwordx4 v4, s[12:15], s44 offen lds
    buffer_load_dwordx4 v5, s[12:15], s44 offen offset:1024 lds
    s_add_u32 s44, s44, 57344
    s_waitcnt vmcnt(8)
    ds_read_b128 v[32:35], v6 offset:12288
    ds_read_b128 v[36:39], v8 offset:12288
    ds_read_b64_tr_b16 v[40:41], v9 offset:12288
    ds_read_b64_tr_b16 v[42:43], v9 offset:12800
    ds_read_b64_tr_b16 v[44:45], v10 offset:12288
    ds_read_b64_tr_b16 v[46:47], v10 offset:12800
    s_waitcnt lgkmcnt(6)
    v_mfma_f32_32x32x16_bf16 v[64:79], v[24:27], v[16:19], v[64:79]
    v_mfma_f32_32x32x16_bf16 v[80:95], v[28:31], v[16:19], v[80:95]
    v_mfma_f32_32x32x16_bf16 v[96:111], v[24:27], v[20:23], v[96:111]
    v_mfma_f32_32x32x16_bf16 v[112:127], v[28:31], v[20:23], v[112:127]
    s_add_u32 s45, s42, 8192
    s_mov_b32 m0, s45
    s_add_u32 s45, s42, 10240
    buffer_load_dwordx4 v3, s[20:23], s43 offen lds
    buffer_load_dwordx4 v3, s[20:23], s43 offen offset:1024 lds
    s_mov_b32 m0, s45
    s_add_u32 s43, s43, 2048
    buffer_load_dwordx4 v4, s[12:15], s44 offen lds
    buffer_load_dwordx4 v5, s[12:15], s44 offen offset:1024 lds
    s_add_u32 s44, s44, 57344
    s_waitcnt vmcnt(8)
    ds_read_b128 v[16:19], v6 offset:0
    ds_read_b128 v[20:23], v8 offset:0
    ds_read_b64_tr_b16 v[24:25], v9 offset:0
    ds_read_b64_tr_b16 v[26:27], v9 offset:512
    ds_read_b64_tr_b16 v[28:29], v10 offset:0
    ds_read_b64_tr_b16 v[30:31], v10 offset:512
    s_waitcnt lgkmcnt(6)
    v_mfma_f32_32x32x16_bf16 v[64:79], v[40:43], v[32:35], v[64:79]
    v_mfma_f32_32x32x16_bf16 v[80:95], v[44:47], v[32:35], v[80:95]
    v_mfma_f32_32x32x16_bf16 v[96:111], v[40:43], v[36:39], v[96:111]
    v_mfma_f32_32x32x16_bf16 v[112:127], v[44:47], v[36:39], v[112:127]
    s_add_u32 s45, s42, 12288
    s_mov_b32 m0, s45
    s_add_u32 s45, s42, 14336
    buffer_load_dwordx4 v3, s[20:23], s43 offen lds
    buffer_load_dwordx4 v3, s[20:23], s43 offen offset:1024 lds
    s_mov_b32 m0, s45
    s_add_u32 s43, s43, 2048
    buffer_load_dwordx4 v4, s[12:15], s44 offen lds
    buffer_load_dwordx4 v5, s[12:15], s44 offen offset:1024 lds
    s_add_u32 s44, s44, 57344
    s_waitcnt vmcnt(8)
    ds_read_b128 v[32:35], v6 offset:4096
    ds_read_b128 v[36:39], v8 offset:4096
    ds_read_b64_tr_b16 v[40:41], v9 offset:4096
    ds_read_b64_tr_b16 v[42:43], v9 offset:4608
    ds_read_b64_tr_b16 v[44:45], v10 offset:4096
    ds_read_b64_tr_b16 v[46:47], v10 offset:4608
    s_waitcnt lgkmcnt(6)
    v_mfma_f32_32x32x16_bf16 v[64:79], v[24:27], v[16:19], v[64:79]
    v_mfma_f32_32x32x16_bf16 v[80:95], v[28:31], v[16:19], v[80:95]
    v_mfma_f32_32x32x16_bf16 v[96:111], v[24:27], v[20:23], v[96:111]
    v_mfma_f32_32x32x16_bf16 v[112:127], v[28:31], v[20:23], v[112:127]
    s_add_u32 s45, s42, 0
    s_mov_b32 m0, s45
    s_add_u32 s45, s42, 2048
    buffer_load_dwordx4 v3, s[20:23], s43 offen lds
    buffer_load_dwordx4 v3, s[20:23], s43 offen offset:1024 lds
    s_mov_b32 m0, s45
    s_add_u32 s43, s43, 2048
    buffer_load_dwordx4 v4, s[12:15], s44 offen lds
    buffer_load_dwordx4 v5, s[12:15], s44 offen offset:1024 lds
    s_add_u32 s44, s44, 57344
    s_waitcnt vmcnt(8)
    ds_read_b128 v[16:19], v6 offset:8192
    ds_read_b128 v[20:23], v8 offset:8192
    ds_read_b64_tr_b16 v[24:25], v9 offset:8192
    ds_read_b64_tr_b16 v[26:27], v9 offset:8704
    ds_read_b64_tr_b16 v[28:29], v10 offset:8192
    ds_read_b64_tr_b16 v[30:31], v10 offset:8704
    s_waitcnt lgkmcnt(6)
    v_mfma_f32_32x32x16_bf16 v[64:79], v[40:43], v[32:35], v[64:79]
    v_mfma_f32_32x32x16_bf16 v[80:95], v[44:47], v[32:35], v[80:95]
    v_mfma_f32_32x32x16_bf16 v[96:111], v[40:43], v[36:39], v[96:111]
    v_mfma_f32_32x32x16_bf16 v[112:127], v[44:47], v[36:39], v[112:127]
    s_add_u32 s45, s42, 4096
    s_mov_b32 m0, s45
    s_add_u32 s45, s42, 6144
    buffer_load_dwordx4 v3, s[20:23], s43 offen lds
    buffer_load_dwordx4 v3, s[20:23], s43 offen offset:1024 lds
    s_mov_b32 m0, s45
    s_add_u32 s43, s43, 2048
    buffer_load_dwordx4 v4, s[12:15], s44 offen lds
    buffer_load_dwordx4 v5, s[12:15], s44 offen offset:1024 lds
    s_add_u32 s44, s44, 57344
    s_waitcnt vmcnt(8)
    ds_read_b128 v[32:35], v6 offset:12288
    ds_read_b128 v[36:39], v8 offset:12288
    ds_read_b64_tr_b16 v[40:41], v9 offset:12288
    ds_read_b64_tr_b16 v[42:43], v9 offset:12800
    ds_read_b64_tr_b16 v[44:45], v10 offset:12288
    ds_read_b64_tr_b16 v[46:47], v10 offset:12800
    s_waitcnt lgkmcnt(6)
    v_mfma_f32_32x32x16_bf16 v[64:79], v[24:27], v[16:19], v[64:79]
    v_mfma_f32_32x32x16_bf16 v[80:95], v[28:31], v[16:19], v[80:95]
    v_mfma_f32_32x32x16_bf16 v[96:111], v[24:27], v[20:23], v[96:111]
    v_mfma_f32_32x32x16_bf16 v[112:127], v[28:31], v[20:23], v[112:127]
    s_add_u32 s45, s42, 8192
    s_mov_b32 m0, s45
    s_add_u32 s45, s42, 10240
    buffer_load_dwordx4 v3, s[20:23], s43 offen lds
    buffer_load_dwordx4 v3, s[20:23], s43 offen offset:1024 lds
    s_mov_b32 m0, s45
    s_add_u32 s43, s43, 2048
    buffer_load_dwordx4 v4, s[12:15], s44 offen lds
    buffer_load_dwordx4 v5, s[12:15], s44 offen offset:1024 lds
    s_add_u32 s44, s44, 57344
    s_waitcnt vmcnt(8)
    ds_read_b128 v[16:19], v6 offset:0
    ds_read_b128 v[20:23], v8 offset:0
    ds_read_b64_tr_b16 v[24:25], v9 offset:0
    ds_read_b64_tr_b16 v[26:27], v9 offset:512
    ds_read_b64_tr_b16 v[28:29], v10 offset:0
    ds_read_b64_tr_b16 v[30:31], v10 offset:512
    s_waitcnt lgkmcnt(6)
    v_mfma_f32_32x32x16_bf16 v[64:79], v[40:43], v[32:35], v[64:79]
    v_mfma_f32_32x32x16_bf16 v[80:95], v[44:47], v[32:35], v[80:95]
    v_mfma_f32_32x32x16_bf16 v[96:111], v[40:43], v[36:39], v[96:111]
    v_mfma_f32_32x32x16_bf16 v[112:127], v[44:47], v[36:39], v[112:127]
    s_add_u32 s45, s42, 12288
    s_mov_b32 m0, s45
    s_add_u32 s45, s42, 14336
    buffer_load_dwordx4 v3, s[20:23], s43 offen lds
    buffer_load_dwordx4 v3, s[20:23], s43 offen offset:1024 lds
    s_mov_b32 m0, s45
    s_add_u32 s43, s43, 2048
    buffer_load_dwordx4 v4, s[12:15], s44 offen lds
    buffer_load_dwordx4 v5, s[12:15], s44 offen offset:1024 lds
    s_add_u32 s44, s44, 57344
    s_waitcnt vmcnt(8)
    ds_read_b128 v[32:35], v6 offset:4096
    ds_read_b128 v[36:39], v8 offset:4096
    ds_read_b64_tr_b16 v[40:41], v9 offset:4096
    ds_read_b64_tr_b16 v[42:43], v9 offset:4608
    ds_read_b64_tr_b16 v[44:45], v10 offset:4096
    ds_read_b64_tr_b16 v[46:47], v10 offset:4608
    s_waitcnt lgkmcnt(6)
    v_mfma_f32_32x32x16_bf16 v[64:79], v[24:27], v[16:19], v[64:79]
    v_mfma_f32_32x32x16_bf16 v[80:95], v[28:31], v[16:19], v[80:95]
    v_mfma_f32_32x32x16_bf16 v[96:111], v[24:27], v[20:23], v[96:111]
    v_mfma_f32_32x32x16_bf16 v[112:127], v[28:31], v[20:23], v[112:127]
    s_add_u32 s45, s42, 0
    s_mov_b32 m0, s45
    s_add_u32 s45, s42, 2048
    buffer_load_dwordx4 v3, s[20:23], s43 offen lds
    buffer_load_dwordx4 v3, s[20:23], s43 offen offset:1024 lds
    s_mov_b32 m0, s45
    s_add_u32 s43, s43, 2048
    buffer_load_dwordx4 v4, s[12:15], s44 offen lds
    buffer_load_dwordx4 v5, s[12:15], s44 offen offset:1024 lds
    s_add_u32 s44, s44, 57344
    s_waitcnt vmcnt(8)
    ds_read_b128 v[16:19], v6 offset:8192
    ds_read_b128 v[20:23], v8 offset:8192
    ds_read_b64_tr_b16 v[24:25], v9 offset:8192
    ds_read_b64_tr_b16 v[26:27], v9 offset:8704
    ds_read_b64_tr_b16 v[28:29], v10 offset:8192
    ds_read_b64_tr_b16 v[30:31], v10 offset:8704
    s_waitcnt lgkmcnt(6)
    v_mfma_f32_32x32x16_bf16 v[64:79], v[40:43], v[32:35], v[64:79]
    v_mfma_f32_32x32x16_bf16 v[80:95], v[44:47], v[32:35], v[80:95]
    v_mfma_f32_32x32x16_bf16 v[96:111], v[40:43], v[36:39], v[96:111]
    v_mfma_f32_32x32x16_bf16 v[112:127], v[44:47], v[36:39], v[112:127]
    s_add_u32 s45, s42, 4096
    s_mov_b32 m0, s45
    s_add_u32 s45, s42, 6144
    buffer_load_dwordx4 v3, s[20:23], s43 offen lds
    buffer_load_dwordx4 v3, s[20:23], s43 offen offset:1024 lds
    s_mov_b32 m0, s45
    s_add_u32 s43, s43, 2048
    buffer_load_dwordx4 v4, s[12:15], s44 offen lds
    buffer_load_dwordx4 v5, s[12:15], s44 offen offset:1024 lds
    s_add_u32 s44, s44, 57344
    s_waitcnt vmcnt(8)
    ds_read_b128 v[32:35], v6 offset:12288
    ds_read_b128 v[36:39], v8 offset:12288
    ds_read_b64_tr_b16 v[40:41], v9 offset:12288
    ds_read_b64_tr_b16 v[42:43], v9 offset:12800
    ds_read_b64_tr_b16 v[44:45], v10 offset:12288
    ds_read_b64_tr_b16 v[46:47], v10 offset:12800
    s_waitcnt lgkmcnt(6)
    v_mfma_f32_32x32x16_bf16 v[64:79], v[24:27], v[16:19], v[64:79]
    v_mfma_f32_32x32x16_bf16 v[80:95], v[28:31], v[16:19], v[80:95]
    v_mfma_f32_32x32x16_bf16 v[96:111], v[24:27], v[20:23], v[96:111]
    v_mfma_f32_32x32x16_bf16 v[112:127], v[28:31], v[20:23], v[112:127]
    s_add_u32 s45, s42, 8192
    s_mov_b32 m0, s45
    s_add_u32 s45, s42, 10240
    buffer_load_dwordx4 v3, s[20:23], s43 offen lds
    buffer_load_dwordx4 v3, s[20:23], s43 offen offset:1024 lds
    s_mov_b32 m0, s45
    s_add_u32 s43, s43, 2048
    buffer_load_dwordx4 v4, s[12:15], s44 offen lds
    buffer_load_dwordx4 v5, s[12:15], s44 offen offset:1024 lds
    s_add_u32 s44, s44, 57344
    s_waitcnt vmcnt(8)
    ds_read_b128 v[16:19], v6 offset:0
    ds_read_b128 v[20:23], v8 offset:0
    ds_read_b64_tr_b16 v[24:25], v9 offset:0
    ds_read_b64_tr_b16 v[26:27], v9 offset:512
    ds_read_b64_tr_b16 v[28:29], v10 offset:0
    ds_read_b64_tr_b16 v[30:31], v10 offset:512
    s_waitcnt lgkmcnt(6)
    v_mfma_f32_32x32x16_bf16 v[64:79], v[40:43], v[32:35], v[64:79]
    v_mfma_f32_32x32x16_bf16 v[80:95], v[44:47], v[32:35], v[80:95]
    v_mfma_f32_32x32x16_bf16 v[96:111], v[40:43], v[36:39], v[96:111]
    v_mfma_f32_32x32x16_bf16 v[112:127], v[44:47], v[36:39], v[112:127]
    s_add_u32 s45, s42, 12288
    s_mov_b32 m0, s45
    s_add_u32 s45, s42, 14336
    buffer_load_dwordx4 v3, s[20:23], s43 offen lds
    buffer_load_dwordx4 v3, s[20:23], s43 offen offset:1024 lds
    s_mov_b32 m0, s45
    s_add_u32 s43, s43, 2048
    buffer_load_dwordx4 v4, s[12:15], s44 offen lds
    buffer_load_dwordx4 v5, s[12:15], s44 offen offset:1024 lds
    s_add_u32 s44, s44, 57344
    s_waitcnt vmcnt(8)
    ds_read_b128 v[32:35], v6 offset:4096
    ds_read_b128 v[36:39], v8 offset:4096
    ds_read_b64_tr_b16 v[40:41], v9 offset:4096
    ds_read_b64_tr_b16 v[42:43], v9 offset:4608
    ds_read_b64_tr_b16 v[44:45], v10 offset:4096
    ds_read_b64_tr_b16 v[46:47], v10 offset:4608
    s_waitcnt lgkmcnt(6)
    v_mfma_f32_32x32x16_bf16 v[64:79], v[24:27], v[16:19], v[64:79]
    v_mfma_f32_32x32x16_bf16 v[80:95], v[28:31], v[16:19], v[80:95]
    v_mfma_f32_32x32x16_bf16 v[96:111], v[24:27], v[20:23], v[96:111]
    v_mfma_f32_32x32x16_bf16 v[112:127], v[28:31], v[20:23], v[112:127]
    s_add_u32 s45, s42, 0
    s_mov_b32 m0, s45
    s_add_u32 s45, s42, 2048
    buffer_load_dwordx4 v3, s[20:23], s43 offen lds
    buffer_load_dwordx4 v3, s[20:23], s43 offen offset:1024 lds
    s_mov_b32 m0, s45
    s_add_u32 s43, s43, 2048
    buffer_load_dwordx4 v4, s[12:15], s44 offen lds
    buffer_load_dwordx4 v5, s[12:15], s44 offen offset:1024 lds
    s_add_u32 s44, s44, 57344
    s_waitcnt vmcnt(8)
    ds_read_b128 v[16:19], v6 offset:8192
    ds_read_b128 v[20:23], v8 offset:8192
    ds_read_b64_tr_b16 v[24:25], v9 offset:8192
    ds_read_b64_tr_b16 v[26:27], v9 offset:8704
    ds_read_b64_tr_b16 v[28:29], v10 offset:8192
    ds_read_b64_tr_b16 v[30:31], v10 offset:8704
    s_waitcnt lgkmcnt(6)
    v_mfma_f32_32x32x16_bf16 v[64:79], v[40:43], v[32:35], v[64:79]
    v_mfma_f32_32x32x16_bf16 v[80:95], v[44:47], v[32:35], v[80:95]
    v_mfma_f32_32x32x16_bf16 v[96:111], v[40:43], v[36:39], v[96:111]
    v_mfma_f32_32x32x16_bf16 v[112:127], v[44:47], v[36:39], v[112:127]
    s_add_u32 s45, s42, 4096
    s_mov_b32 m0, s45
    s_add_u32 s45, s42, 6144
    buffer_load_dwordx4 v3, s[20:23], s43 offen lds
    buffer_load_dwordx4 v3, s[20:23], s43 offen offset:1024 lds
    s_mov_b32 m0, s45
    s_add_u32 s43, s43, 2048
    buffer_load_dwordx4 v4, s[12:15], s44 offen lds
    buffer_load_dwordx4 v5, s[12:15], s44 offen offset:1024 lds
    s_add_u32 s44, s44, 57344
    s_waitcnt vmcnt(8)
    ds_read_b128 v[32:35], v6 offset:12288
    ds_read_b128 v[36:39], v8 offset:12288
    ds_read_b64_tr_b16 v[40:41], v9 offset:12288
    ds_read_b64_tr_b16 v[42:43], v9 offset:12800
    ds_read_b64_tr_b16 v[44:45], v10 offset:12288
    ds_read_b64_tr_b16 v[46:47], v10 offset:12800
    s_waitcnt lgkmcnt(6)
    v_mfma_f32_32x32x16_bf16 v[64:79], v[24:27], v[16:19], v[64:79]
    v_mfma_f32_32x32x16_bf16 v[80:95], v[28:31], v[16:19], v[80:95]
    v_mfma_f32_32x32x16_bf16 v[96:111], v[24:27], v[20:23], v[96:111]
    v_mfma_f32_32x32x16_bf16 v[112:127], v[28:31], v[20:23], v[112:127]
    s_add_u32 s45, s42, 8192
    s_mov_b32 m0, s45
    s_add_u32 s45, s42, 10240
    buffer_load_dwordx4 v3, s[20:23], s43 offen lds
    buffer_load_dwordx4 v3, s[20:23], s43 offen offset:1024 lds
    s_mov_b32 m0, s45
    s_add_u32 s43, s43, 2048
    buffer_load_dwordx4 v4, s[12:15], s44 offen lds
    buffer_load_dwordx4 v5, s[12:15], s44 offen offset:1024 lds
    s_add_u32 s44, s44, 57344
    s_waitcnt vmcnt(8)
    ds_read_b128 v[16:19], v6 offset:0
    ds_read_b128 v[20:23], v8 offset:0
    ds_read_b64_tr_b16 v[24:25], v9 offset:0
    ds_read_b64_tr_b16 v[26:27], v9 offset:512
    ds_read_b64_tr_b16 v[28:29], v10 offset:0
    ds_read_b64_tr_b16 v[30:31], v10 offset:512
    s_waitcnt lgkmcnt(6)
    v_mfma_f32_32x32x16_bf16 v[64:79], v[40:43], v[32:35], v[64:79]
    v_mfma_f32_32x32x16_bf16 v[80:95], v[44:47], v[32:35], v[80:95]
    v_mfma_f32_32x32x16_bf16 v[96:111], v[40:43], v[36:39], v[96:111]
    v_mfma_f32_32x32x16_bf16 v[112:127], v[44:47], v[36:39], v[112:127]
    s_add_u32 s45, s42, 12288
    s_mov_b32 m0, s45
    s_add_u32 s45, s42, 14336
    buffer_load_dwordx4 v3, s[20:23], s43 offen lds
    buffer_load_dwordx4 v3, s[20:23], s43 offen offset:1024 lds
    s_mov_b32 m0, s45
    s_add_u32 s43, s43, 2048
    buffer_load_dwordx4 v4, s[12:15], s44 offen lds
    buffer_load_dwordx4 v5, s[12:15], s44 offen offset:1024 lds
    s_add_u32 s44, s44, 57344
    s_waitcnt vmcnt(8)
    ds_read_b128 v[32:35], v6 offset:4096
    ds_read_b128 v[36:39], v8 offset:4096
    ds_read_b64_tr_b16 v[40:41], v9 offset:4096
    ds_read_b64_tr_b16 v[42:43], v9 offset:4608
    ds_read_b64_tr_b16 v[44:45], v10 offset:4096
    ds_read_b64_tr_b16 v[46:47], v10 offset:4608
    s_waitcnt lgkmcnt(6)
    v_mfma_f32_32x32x16_bf16 v[64:79], v[24:27], v[16:19], v[64:79]
    v_mfma_f32_32x32x16_bf16 v[80:95], v[28:31], v[16:19], v[80:95]
    v_mfma_f32_32x32x16_bf16 v[96:111], v[24:27], v[20:23], v[96:111]
    v_mfma_f32_32x32x16_bf16 v[112:127], v[28:31], v[20:23], v[112:127]
    s_waitcnt vmcnt(4)
    ds_read_b128 v[16:19], v6 offset:8192
    ds_read_b128 v[20:23], v8 offset:8192
    ds_read_b64_tr_b16 v[24:25], v9 offset:8192
    ds_read_b64_tr_b16 v[26:27], v9 offset:8704
    ds_read_b64_tr_b16 v[28:29], v10 offset:8192
    ds_read_b64_tr_b16 v[30:31], v10 offset:8704
    s_waitcnt lgkmcnt(6)
    v_mfma_f32_32x32x16_bf16 v[64:79], v[40:43], v[32:35], v[64:79]
    v_mfma_f32_32x32x16_bf16 v[80:95], v[44:47], v[32:35], v[80:95]
    v_mfma_f32_32x32x16_bf16 v[96:111], v[40:43], v[36:39], v[96:111]
    v_mfma_f32_32x32x16_bf16 v[112:127], v[44:47], v[36:39], v[112:127]
    s_waitcnt vmcnt(0)
    ds_read_b128 v[32:35], v6 offset:12288
    ds_read_b128 v[36:39], v8 offset:12288
    ds_read_b64_tr_b16 v[40:41], v9 offset:12288
    ds_read_b64_tr_b16 v[42:43], v9 offset:12800
    ds_read_b64_tr_b16 v[44:45], v10 offset:12288
    ds_read_b64_tr_b16 v[46:47], v10 offset:12800
    s_waitcnt lgkmcnt(6)
    v_mfma_f32_32x32x16_bf16 v[64:79], v[24:27], v[16:19], v[64:79]
    v_mfma_f32_32x32x16_bf16 v[80:95], v[28:31], v[16:19], v[80:95]
    v_mfma_f32_32x32x16_bf16 v[96:111], v[24:27], v[20:23], v[96:111]
    v_mfma_f32_32x32x16_bf16 v[112:127], v[28:31], v[20:23], v[112:127]
    s_waitcnt lgkmcnt(0)
    v_mfma_f32_32x32x16_bf16 v[64:79], v[40:43], v[32:35], v[64:79]
    v_mfma_f32_32x32x16_bf16 v[80:95], v[44:47], v[32:35], v[80:95]
    v_mfma_f32_32x32x16_bf16 v[96:111], v[40:43], v[36:39], v[96:111]
    v_mfma_f32_32x32x16_bf16 v[112:127], v[44:47], v[36:39], v[112:127]
    v_lshlrev_b32 v15, 4, v1
    v_add_u32 v2, s42, v15
    s_nop 9
    ds_write_b128 v2, v[80:83] offset:0
    ds_write_b128 v2, v[84:87] offset:1024
    ds_write_b128 v2, v[88:91] offset:2048
    ds_write_b128 v2, v[92:95] offset:3072
    ds_write_b128 v2, v[96:99] offset:4096
    ds_write_b128 v2, v[100:103] offset:5120
    ds_write_b128 v2, v[104:107] offset:6144
    ds_write_b128 v2, v[108:111] offset:7168
    ds_write_b128 v2, v[112:115] offset:8192
    ds_write_b128 v2, v[116:119] offset:9216
    ds_write_b128 v2, v[120:123] offset:10240
    ds_write_b128 v2, v[124:127] offset:11264
    s_xor_b32 s45, s40, 1
    s_mul_i32 s45, s45, 16384
    v_add_u32 v17, s45, v15
    s_xor_b32 s45, s40, 2
    s_mul_i32 s45, s45, 16384
    v_add_u32 v18, s45, v15
    s_xor_b32 s45, s40, 3
    s_mul_i32 s45, s45, 16384
    v_add_u32 v19, s45, v15
    s_waitcnt lgkmcnt(0)
    s_barrier
    ds_read_b128 v[80:83], v17 offset:0
    ds_read_b128 v[84:87], v17 offset:1024
    ds_read_b128 v[88:91], v17 offset:2048
    ds_read_b128 v[92:95], v17 offset:3072
    ds_read_b128 v[96:99], v18 offset:4096
    ds_read_b128 v[100:103], v18 offset:5120
    ds_read_b128 v[104:107], v18 offset:6144
    ds_read_b128 v[108:111], v18 offset:7168
    ds_read_b128 v[112:115], v19 offset:8192
    ds_read_b128 v[116:119], v19 offset:9216
    ds_read_b128 v[120:123], v19 offset:10240
    ds_read_b128 v[124:127], v19 offset:11264
    s_waitcnt lgkmcnt(8)
    v_add_f32 v64, v64, v80
    v_add_f32 v65, v65, v81
    v_add_f32 v66, v66, v82
    v_add_f32 v67, v67, v83
    v_add_f32 v68, v68, v84
    v_add_f32 v69, v69, v85
    v_add_f32 v70, v70, v86
    v_add_f32 v71, v71, v87
    v_add_f32 v72, v72, v88
    v_add_f32 v73, v73, v89
    v_add_f32 v74, v74, v90
    v_add_f32 v75, v75, v91
    v_add_f32 v76, v76, v92
    v_add_f32 v77, v77, v93
    v_add_f32 v78, v78, v94
    v_add_f32 v79, v79, v95
    s_waitcnt lgkmcnt(4)
    v_add_f32 v64, v64, v96
    v_add_f32 v65, v65, v97
    v_add_f32 v66, v66, v98
    v_add_f32 v67, v67, v99
    v_add_f32 v68, v68, v100
    v_add_f32 v69, v69, v101
    v_add_f32 v70, v70, v102
    v_add_f32 v71, v71, v103
    v_add_f32 v72, v72, v104
    v_add_f32 v73, v73, v105
    v_add_f32 v74, v74, v106
    v_add_f32 v75, v75, v107
    v_add_f32 v76, v76, v108
    v_add_f32 v77, v77, v109
    v_add_f32 v78, v78, v110
    v_add_f32 v79, v79, v111
    s_waitcnt lgkmcnt(0)
    v_add_f32 v64, v64, v112
    v_add_f32 v65, v65, v113
    v_add_f32 v66, v66, v114
    v_add_f32 v67, v67, v115
    v_add_f32 v68, v68, v116
    v_add_f32 v69, v69, v117
    v_add_f32 v70, v70, v118
    v_add_f32 v71, v71, v119
    v_add_f32 v72, v72, v120
    v_add_f32 v73, v73, v121
    v_add_f32 v74, v74, v122
    v_add_f32 v75, v75, v123
    v_add_f32 v76, v76, v124
    v_add_f32 v77, v77, v125
    v_add_f32 v78, v78, v126
    v_add_f32 v79, v79, v127
    s_mov_b32 s50, 0xffff0000
    s_mov_b32 s51, 0xc0135761
    s_mov_b32 s52, 0xbdd2d3e8
    v_cvt_pk_bf16_f32 v40, v64, v65
    v_lshlrev_b32 v64, 16, v40
    v_and_b32 v65, s50, v40
    v_lshlrev_b32 v40, 16, v48
    v_and_b32 v41, s50, v48
    v_add_f32 v64, v64, v40
    v_add_f32 v65, v65, v41
    v_cvt_pk_bf16_f32 v40, v64, v65
    v_lshlrev_b32 v64, 16, v40
    v_and_b32 v65, s50, v40
    v_mul_f32 v42, v64, v64
    v_mul_f32 v44, s52, v42
    v_add_f32 v44, s51, v44
    v_mul_f32 v42, v64, v44
    v_exp_f32 v42, v42
    v_mul_f32 v43, v65, v65
    v_mul_f32 v44, s52, v43
    v_add_f32 v44, s51, v44
    v_mul_f32 v43, v65, v44
    v_exp_f32 v43, v43
    s_nop 0
    v_add_f32 v42, 1.0, v42
    v_rcp_f32 v42, v42
    v_add_f32 v43, 1.0, v43
    v_rcp_f32 v43, v43
    s_nop 0
    v_mul_f32 v42, v64, v42
    v_mul_f32 v43, v65, v43
    v_cvt_pk_bf16_f32 v56, v42, v43
    v_cvt_pk_bf16_f32 v40, v66, v67
    v_lshlrev_b32 v66, 16, v40
    v_and_b32 v67, s50, v40
    v_lshlrev_b32 v40, 16, v49
    v_and_b32 v41, s50, v49
    v_add_f32 v66, v66, v40
    v_add_f32 v67, v67, v41
    v_cvt_pk_bf16_f32 v40, v66, v67
    v_lshlrev_b32 v66, 16, v40
    v_and_b32 v67, s50, v40
    v_mul_f32 v42, v66, v66
    v_mul_f32 v44, s52, v42
    v_add_f32 v44, s51, v44
    v_mul_f32 v42, v66, v44
    v_exp_f32 v42, v42
    v_mul_f32 v43, v67, v67
    v_mul_f32 v44, s52, v43
    v_add_f32 v44, s51, v44
    v_mul_f32 v43, v67, v44
    v_exp_f32 v43, v43
    s_nop 0
    v_add_f32 v42, 1.0, v42
    v_rcp_f32 v42, v42
    v_add_f32 v43, 1.0, v43
    v_rcp_f32 v43, v43
    s_nop 0
    v_mul_f32 v42, v66, v42
    v_mul_f32 v43, v67, v43
    v_cvt_pk_bf16_f32 v57, v42, v43
    v_cvt_pk_bf16_f32 v40, v68, v69
    v_lshlrev_b32 v68, 16, v40
    v_and_b32 v69, s50, v40
    v_lshlrev_b32 v40, 16, v50
    v_and_b32 v41, s50, v50
    v_add_f32 v68, v68, v40
    v_add_f32 v69, v69, v41
    v_cvt_pk_bf16_f32 v40, v68, v69
    v_lshlrev_b32 v68, 16, v40
    v_and_b32 v69, s50, v40
    v_mul_f32 v42, v68, v68
    v_mul_f32 v44, s52, v42
    v_add_f32 v44, s51, v44
    v_mul_f32 v42, v68, v44
    v_exp_f32 v42, v42
    v_mul_f32 v43, v69, v69
    v_mul_f32 v44, s52, v43
    v_add_f32 v44, s51, v44
    v_mul_f32 v43, v69, v44
    v_exp_f32 v43, v43
    s_nop 0
    v_add_f32 v42, 1.0, v42
    v_rcp_f32 v42, v42
    v_add_f32 v43, 1.0, v43
    v_rcp_f32 v43, v43
    s_nop 0
    v_mul_f32 v42, v68, v42
    v_mul_f32 v43, v69, v43
    v_cvt_pk_bf16_f32 v58, v42, v43
    v_cvt_pk_bf16_f32 v40, v70, v71
    v_lshlrev_b32 v70, 16, v40
    v_and_b32 v71, s50, v40
    v_lshlrev_b32 v40, 16, v51
    v_and_b32 v41, s50, v51
    v_add_f32 v70, v70, v40
    v_add_f32 v71, v71, v41
    v_cvt_pk_bf16_f32 v40, v70, v71
    v_lshlrev_b32 v70, 16, v40
    v_and_b32 v71, s50, v40
    v_mul_f32 v42, v70, v70
    v_mul_f32 v44, s52, v42
    v_add_f32 v44, s51, v44
    v_mul_f32 v42, v70, v44
    v_exp_f32 v42, v42
    v_mul_f32 v43, v71, v71
    v_mul_f32 v44, s52, v43
    v_add_f32 v44, s51, v44
    v_mul_f32 v43, v71, v44
    v_exp_f32 v43, v43
    s_nop 0
    v_add_f32 v42, 1.0, v42
    v_rcp_f32 v42, v42
    v_add_f32 v43, 1.0, v43
    v_rcp_f32 v43, v43
    s_nop 0
    v_mul_f32 v42, v70, v42
    v_mul_f32 v43, v71, v43
    v_cvt_pk_bf16_f32 v59, v42, v43
    v_cvt_pk_bf16_f32 v40, v72, v73
    v_lshlrev_b32 v72, 16, v40
    v_and_b32 v73, s50, v40
    v_lshlrev_b32 v40, 16, v52
    v_and_b32 v41, s50, v52
    v_add_f32 v72, v72, v40
    v_add_f32 v73, v73, v41
    v_cvt_pk_bf16_f32 v40, v72, v73
    v_lshlrev_b32 v72, 16, v40
    v_and_b32 v73, s50, v40
    v_mul_f32 v42, v72, v72
    v_mul_f32 v44, s52, v42
    v_add_f32 v44, s51, v44
    v_mul_f32 v42, v72, v44
    v_exp_f32 v42, v42
    v_mul_f32 v43, v73, v73
    v_mul_f32 v44, s52, v43
    v_add_f32 v44, s51, v44
    v_mul_f32 v43, v73, v44
    v_exp_f32 v43, v43
    s_nop 0
    v_add_f32 v42, 1.0, v42
    v_rcp_f32 v42, v42
    v_add_f32 v43, 1.0, v43
    v_rcp_f32 v43, v43
    s_nop 0
    v_mul_f32 v42, v72, v42
    v_mul_f32 v43, v73, v43
    v_cvt_pk_bf16_f32 v60, v42, v43
    v_cvt_pk_bf16_f32 v40, v74, v75
    v_lshlrev_b32 v74, 16, v40
    v_and_b32 v75, s50, v40
    v_lshlrev_b32 v40, 16, v53
    v_and_b32 v41, s50, v53
    v_add_f32 v74, v74, v40
    v_add_f32 v75, v75, v41
    v_cvt_pk_bf16_f32 v40, v74, v75
    v_lshlrev_b32 v74, 16, v40
    v_and_b32 v75, s50, v40
    v_mul_f32 v42, v74, v74
    v_mul_f32 v44, s52, v42
    v_add_f32 v44, s51, v44
    v_mul_f32 v42, v74, v44
    v_exp_f32 v42, v42
    v_mul_f32 v43, v75, v75
    v_mul_f32 v44, s52, v43
    v_add_f32 v44, s51, v44
    v_mul_f32 v43, v75, v44
    v_exp_f32 v43, v43
    s_nop 0
    v_add_f32 v42, 1.0, v42
    v_rcp_f32 v42, v42
    v_add_f32 v43, 1.0, v43
    v_rcp_f32 v43, v43
    s_nop 0
    v_mul_f32 v42, v74, v42
    v_mul_f32 v43, v75, v43
    v_cvt_pk_bf16_f32 v61, v42, v43
    v_cvt_pk_bf16_f32 v40, v76, v77
    v_lshlrev_b32 v76, 16, v40
    v_and_b32 v77, s50, v40
    v_lshlrev_b32 v40, 16, v54
    v_and_b32 v41, s50, v54
    v_add_f32 v76, v76, v40
    v_add_f32 v77, v77, v41
    v_cvt_pk_bf16_f32 v40, v76, v77
    v_lshlrev_b32 v76, 16, v40
    v_and_b32 v77, s50, v40
    v_mul_f32 v42, v76, v76
    v_mul_f32 v44, s52, v42
    v_add_f32 v44, s51, v44
    v_mul_f32 v42, v76, v44
    v_exp_f32 v42, v42
    v_mul_f32 v43, v77, v77
    v_mul_f32 v44, s52, v43
    v_add_f32 v44, s51, v44
    v_mul_f32 v43, v77, v44
    v_exp_f32 v43, v43
    s_nop 0
    v_add_f32 v42, 1.0, v42
    v_rcp_f32 v42, v42
    v_add_f32 v43, 1.0, v43
    v_rcp_f32 v43, v43
    s_nop 0
    v_mul_f32 v42, v76, v42
    v_mul_f32 v43, v77, v43
    v_cvt_pk_bf16_f32 v62, v42, v43
    v_cvt_pk_bf16_f32 v40, v78, v79
    v_lshlrev_b32 v78, 16, v40
    v_and_b32 v79, s50, v40
    v_lshlrev_b32 v40, 16, v55
    v_and_b32 v41, s50, v55
    v_add_f32 v78, v78, v40
    v_add_f32 v79, v79, v41
    v_cvt_pk_bf16_f32 v40, v78, v79
    v_lshlrev_b32 v78, 16, v40
    v_and_b32 v79, s50, v40
    v_mul_f32 v42, v78, v78
    v_mul_f32 v44, s52, v42
    v_add_f32 v44, s51, v44
    v_mul_f32 v42, v78, v44
    v_exp_f32 v42, v42
    v_mul_f32 v43, v79, v79
    v_mul_f32 v44, s52, v43
    v_add_f32 v44, s51, v44
    v_mul_f32 v43, v79, v44
    v_exp_f32 v43, v43
    s_nop 0
    v_add_f32 v42, 1.0, v42
    v_rcp_f32 v42, v42
    v_add_f32 v43, 1.0, v43
    v_rcp_f32 v43, v43
    s_nop 0
    v_mul_f32 v42, v78, v42
    v_mul_f32 v43, v79, v43
    v_cvt_pk_bf16_f32 v63, v42, v43
    s_mul_i32 s51, s54, 224
    s_lshl_b32 s52, s55, 3
    s_add_u32 s51, s51, s52
    s_lshl_b32 s52, s47, 2
    s_add_u32 s51, s51, s52
    s_lshl_b32 s51, s51, 10
    s_lshl_b32 s52, s46, 9
    s_add_u32 s51, s51, s52
    s_add_u32 s51, s51, 8978432
    v_and_b32 v13, 31, v1
    v_lshlrev_b32 v13, 4, v13
    v_lshl_add_u32 v13, v12, 7, v13
    v_permlane32_swap_b32 v56, v58
    v_permlane32_swap_b32 v57, v59
    v_permlane32_swap_b32 v60, v62
    v_permlane32_swap_b32 v61, v63
    buffer_store_dwordx4 v[56:59], v13, s[20:23], s51 offen offset:0 sc1
    buffer_store_dwordx4 v[60:63], v13, s[20:23], s51 offen offset:2048 sc1
    s_branch k2_done
k2_conv:
    s_mov_b32 s3, s2
    s_load_dwordx2 s[4:5], s[0:1], 64
    s_load_dwordx2 s[32:33], s[0:1], 96
    v_lshrrev_b32 v3, 7, v0
    v_and_b32 v9, 127, v0
    s_lshl_b32 s6, s3, 1
    v_add_u32 v5, s6, v3
    v_lshlrev_b32 v6, 1, v5
    v_mul_u32_u24 v10, 17536, v3
    v_lshl_add_u32 v11, v9, 4, v10
    v_lshlrev_b32 v1, 12, v5
    v_lshl_add_u32 v1, v9, 4, v1
    v_mul_u32_u24 v2, 3072, v5
    v_lshl_add_u32 v2, v9, 4, v2
    v_add_u32 v12, 4096, v1
    s_waitcnt lgkmcnt(0)
    s_mov_b32 s20, s8
    s_and_b32 s21, s9, 0xffff
    s_mov_b32 s22, 12910592
    s_mov_b32 s23, 0x00020000
    s_mov_b32 s10, 4259840
    s_mov_b32 s24, 2097120
    buffer_load_dwordx4 v[40:43], v2, s[20:23], s10 offen
    buffer_load_dwordx4 v[44:47], v2, s[20:23], s10 offen offset:2048
    global_load_ushort v6, v6, s[4:5]
    buffer_load_dwordx4 v[16:19], v1, s[20:23], s24 offen offset:0
    buffer_load_dword v20, v1, s[20:23], s24 offen offset:16
    buffer_load_dwordx4 v[24:27], v1, s[20:23], s24 offen offset:2048
    buffer_load_dword v28, v1, s[20:23], s24 offen offset:2064
    buffer_load_dwordx4 v[32:35], v12, s[20:23], s24 offen
    buffer_load_dword v36, v12, s[20:23], s24 offen offset:16
    s_mov_b32 s30, 0xffff0000
    v_lshlrev_b32 v13, 12, v3
    v_lshl_add_u32 v14, v9, 4, v13
    v_lshlrev_b32 v12, 3, v9
    v_sub_u32 v12, 2047, v12
    v_subrev_u32 v80, 0, v12
    v_cvt_f32_u32 v80, v80
    v_subrev_u32 v81, 1, v12
    v_cvt_f32_u32 v81, v81
    v_subrev_u32 v82, 2, v12
    v_cvt_f32_u32 v82, v82
    v_subrev_u32 v83, 3, v12
    v_cvt_f32_u32 v83, v83
    v_subrev_u32 v84, 4, v12
    v_cvt_f32_u32 v84, v84
    v_subrev_u32 v85, 5, v12
    v_cvt_f32_u32 v85, v85
    v_subrev_u32 v86, 6, v12
    v_cvt_f32_u32 v86, v86
    v_subrev_u32 v87, 7, v12
    v_cvt_f32_u32 v87, v87
    v_subrev_u32 v88, 1024, v12
    v_cvt_f32_u32 v88, v88
    v_subrev_u32 v89, 1025, v12
    v_cvt_f32_u32 v89, v89
    v_subrev_u32 v90, 1026, v12
    v_cvt_f32_u32 v90, v90
    v_subrev_u32 v91, 1027, v12
    v_cvt_f32_u32 v91, v91
    v_subrev_u32 v92, 1028, v12
    v_cvt_f32_u32 v92, v92
    v_subrev_u32 v93, 1029, v12
    v_cvt_f32_u32 v93, v93
    v_subrev_u32 v94, 1030, v12
    v_cvt_f32_u32 v94, v94
    v_subrev_u32 v95, 1031, v12
    v_cvt_f32_u32 v95, v95
    v_cvt_pk_bf16_f32 v48, v80, v81
    v_lshlrev_b32 v80, 16, v48
    v_and_b32 v81, s30, v48
    v_cvt_pk_bf16_f32 v48, v82, v83
    v_lshlrev_b32 v82, 16, v48
    v_and_b32 v83, s30, v48
    v_cvt_pk_bf16_f32 v48, v84, v85
    v_lshlrev_b32 v84, 16, v48
    v_and_b32 v85, s30, v48
    v_cvt_pk_bf16_f32 v48, v86, v87
    v_lshlrev_b32 v86, 16, v48
    v_and_b32 v87, s30, v48
    v_cvt_pk_bf16_f32 v48, v88, v89
    v_lshlrev_b32 v88, 16, v48
    v_and_b32 v89, s30, v48
    v_cvt_pk_bf16_f32 v48, v90, v91
    v_lshlrev_b32 v90, 16, v48
    v_and_b32 v91, s30, v48
    v_cvt_pk_bf16_f32 v48, v92, v93
    v_lshlrev_b32 v92, 16, v48
    v_and_b32 v93, s30, v48
    v_cvt_pk_bf16_f32 v48, v94, v95
    v_lshlrev_b32 v94, 16, v48
    v_and_b32 v95, s30, v48
    v_cvt_u32_f32 v48, v80
    v_lshrrev_b32 v49, 23, v80
    v_subrev_u32 v49, 134, v49
    v_med3_i32 v49, v49, 0, 3
    v_lshrrev_b32 v50, 7, v48
    v_and_b32 v51, 7, v48
    v_lshl_or_b32 v50, v50, 3, v51
    v_lshrrev_b32 v50, v49, v50
    v_lshl_add_u32 v50, v49, 3, v50
    v_bfe_u32 v51, v48, 3, 4
    v_lshl_add_u32 v50, v50, 4, v51
    v_lshl_add_u32 v80, v50, 2, v13
    v_cvt_u32_f32 v48, v81
    v_lshrrev_b32 v49, 23, v81
    v_subrev_u32 v49, 134, v49
    v_med3_i32 v49, v49, 0, 3
    v_lshrrev_b32 v50, 7, v48
    v_and_b32 v51, 7, v48
    v_lshl_or_b32 v50, v50, 3, v51
    v_lshrrev_b32 v50, v49, v50
    v_lshl_add_u32 v50, v49, 3, v50
    v_bfe_u32 v51, v48, 3, 4
    v_lshl_add_u32 v50, v50, 4, v51
    v_lshl_add_u32 v81, v50, 2, v13
    v_cvt_u32_f32 v48, v82
    v_lshrrev_b32 v49, 23, v82
    v_subrev_u32 v49, 134, v49
    v_med3_i32 v49, v49, 0, 3
    v_lshrrev_b32 v50, 7, v48
    v_and_b32 v51, 7, v48
    v_lshl_or_b32 v50, v50, 3, v51
    v_lshrrev_b32 v50, v49, v50
    v_lshl_add_u32 v50, v49, 3, v50
    v_bfe_u32 v51, v48, 3, 4
    v_lshl_add_u32 v50, v50, 4, v51
    v_lshl_add_u32 v82, v50, 2, v13
    v_cvt_u32_f32 v48, v83
    v_lshrrev_b32 v49, 23, v83
    v_subrev_u32 v49, 134, v49
    v_med3_i32 v49, v49, 0, 3
    v_lshrrev_b32 v50, 7, v48
    v_and_b32 v51, 7, v48
    v_lshl_or_b32 v50, v50, 3, v51
    v_lshrrev_b32 v50, v49, v50
    v_lshl_add_u32 v50, v49, 3, v50
    v_bfe_u32 v51, v48, 3, 4
    v_lshl_add_u32 v50, v50, 4, v51
    v_lshl_add_u32 v83, v50, 2, v13
    v_cvt_u32_f32 v48, v84
    v_lshrrev_b32 v49, 23, v84
    v_subrev_u32 v49, 134, v49
    v_med3_i32 v49, v49, 0, 3
    v_lshrrev_b32 v50, 7, v48
    v_and_b32 v51, 7, v48
    v_lshl_or_b32 v50, v50, 3, v51
    v_lshrrev_b32 v50, v49, v50
    v_lshl_add_u32 v50, v49, 3, v50
    v_bfe_u32 v51, v48, 3, 4
    v_lshl_add_u32 v50, v50, 4, v51
    v_lshl_add_u32 v84, v50, 2, v13
    v_cvt_u32_f32 v48, v85
    v_lshrrev_b32 v49, 23, v85
    v_subrev_u32 v49, 134, v49
    v_med3_i32 v49, v49, 0, 3
    v_lshrrev_b32 v50, 7, v48
    v_and_b32 v51, 7, v48
    v_lshl_or_b32 v50, v50, 3, v51
    v_lshrrev_b32 v50, v49, v50
    v_lshl_add_u32 v50, v49, 3, v50
    v_bfe_u32 v51, v48, 3, 4
    v_lshl_add_u32 v50, v50, 4, v51
    v_lshl_add_u32 v85, v50, 2, v13
    v_cvt_u32_f32 v48, v86
    v_lshrrev_b32 v49, 23, v86
    v_subrev_u32 v49, 134, v49
    v_med3_i32 v49, v49, 0, 3
    v_lshrrev_b32 v50, 7, v48
    v_and_b32 v51, 7, v48
    v_lshl_or_b32 v50, v50, 3, v51
    v_lshrrev_b32 v50, v49, v50
    v_lshl_add_u32 v50, v49, 3, v50
    v_bfe_u32 v51, v48, 3, 4
    v_lshl_add_u32 v50, v50, 4, v51
    v_lshl_add_u32 v86, v50, 2, v13
    v_cvt_u32_f32 v48, v87
    v_lshrrev_b32 v49, 23, v87
    v_subrev_u32 v49, 134, v49
    v_med3_i32 v49, v49, 0, 3
    v_lshrrev_b32 v50, 7, v48
    v_and_b32 v51, 7, v48
    v_lshl_or_b32 v50, v50, 3, v51
    v_lshrrev_b32 v50, v49, v50
    v_lshl_add_u32 v50, v49, 3, v50
    v_bfe_u32 v51, v48, 3, 4
    v_lshl_add_u32 v50, v50, 4, v51
    v_lshl_add_u32 v87, v50, 2, v13
    v_cvt_u32_f32 v48, v88
    v_lshrrev_b32 v49, 23, v88
    v_subrev_u32 v49, 134, v49
    v_med3_i32 v49, v49, 0, 3
    v_lshrrev_b32 v50, 7, v48
    v_and_b32 v51, 7, v48
    v_lshl_or_b32 v50, v50, 3, v51
    v_lshrrev_b32 v50, v49, v50
    v_lshl_add_u32 v50, v49, 3, v50
    v_bfe_u32 v51, v48, 3, 4
    v_lshl_add_u32 v50, v50, 4, v51
    v_lshl_add_u32 v88, v50, 2, v13
    v_cvt_u32_f32 v48, v89
    v_lshrrev_b32 v49, 23, v89
    v_subrev_u32 v49, 134, v49
    v_med3_i32 v49, v49, 0, 3
    v_lshrrev_b32 v50, 7, v48
    v_and_b32 v51, 7, v48
    v_lshl_or_b32 v50, v50, 3, v51
    v_lshrrev_b32 v50, v49, v50
    v_lshl_add_u32 v50, v49, 3, v50
    v_bfe_u32 v51, v48, 3, 4
    v_lshl_add_u32 v50, v50, 4, v51
    v_lshl_add_u32 v89, v50, 2, v13
    v_cvt_u32_f32 v48, v90
    v_lshrrev_b32 v49, 23, v90
    v_subrev_u32 v49, 134, v49
    v_med3_i32 v49, v49, 0, 3
    v_lshrrev_b32 v50, 7, v48
    v_and_b32 v51, 7, v48
    v_lshl_or_b32 v50, v50, 3, v51
    v_lshrrev_b32 v50, v49, v50
    v_lshl_add_u32 v50, v49, 3, v50
    v_bfe_u32 v51, v48, 3, 4
    v_lshl_add_u32 v50, v50, 4, v51
    v_lshl_add_u32 v90, v50, 2, v13
    v_cvt_u32_f32 v48, v91
    v_lshrrev_b32 v49, 23, v91
    v_subrev_u32 v49, 134, v49
    v_med3_i32 v49, v49, 0, 3
    v_lshrrev_b32 v50, 7, v48
    v_and_b32 v51, 7, v48
    v_lshl_or_b32 v50, v50, 3, v51
    v_lshrrev_b32 v50, v49, v50
    v_lshl_add_u32 v50, v49, 3, v50
    v_bfe_u32 v51, v48, 3, 4
    v_lshl_add_u32 v50, v50, 4, v51
    v_lshl_add_u32 v91, v50, 2, v13
    v_cvt_u32_f32 v48, v92
    v_lshrrev_b32 v49, 23, v92
    v_subrev_u32 v49, 134, v49
    v_med3_i32 v49, v49, 0, 3
    v_lshrrev_b32 v50, 7, v48
    v_and_b32 v51, 7, v48
    v_lshl_or_b32 v50, v50, 3, v51
    v_lshrrev_b32 v50, v49, v50
    v_lshl_add_u32 v50, v49, 3, v50
    v_bfe_u32 v51, v48, 3, 4
    v_lshl_add_u32 v50, v50, 4, v51
    v_lshl_add_u32 v92, v50, 2, v13
    v_cvt_u32_f32 v48, v93
    v_lshrrev_b32 v49, 23, v93
    v_subrev_u32 v49, 134, v49
    v_med3_i32 v49, v49, 0, 3
    v_lshrrev_b32 v50, 7, v48
    v_and_b32 v51, 7, v48
    v_lshl_or_b32 v50, v50, 3, v51
    v_lshrrev_b32 v50, v49, v50
    v_lshl_add_u32 v50, v49, 3, v50
    v_bfe_u32 v51, v48, 3, 4
    v_lshl_add_u32 v50, v50, 4, v51
    v_lshl_add_u32 v93, v50, 2, v13
    v_cvt_u32_f32 v48, v94
    v_lshrrev_b32 v49, 23, v94
    v_subrev_u32 v49, 134, v49
    v_med3_i32 v49, v49, 0, 3
    v_lshrrev_b32 v50, 7, v48
    v_and_b32 v51, 7, v48
    v_lshl_or_b32 v50, v50, 3, v51
    v_lshrrev_b32 v50, v49, v50
    v_lshl_add_u32 v50, v49, 3, v50
    v_bfe_u32 v51, v48, 3, 4
    v_lshl_add_u32 v50, v50, 4, v51
    v_lshl_add_u32 v94, v50, 2, v13
    v_cvt_u32_f32 v48, v95
    v_lshrrev_b32 v49, 23, v95
    v_subrev_u32 v49, 134, v49
    v_med3_i32 v49, v49, 0, 3
    v_lshrrev_b32 v50, 7, v48
    v_and_b32 v51, 7, v48
    v_lshl_or_b32 v50, v50, 3, v51
    v_lshrrev_b32 v50, v49, v50
    v_lshl_add_u32 v50, v49, 3, v50
    v_bfe_u32 v51, v48, 3, 4
    v_lshl_add_u32 v50, v50, 4, v51
    v_lshl_add_u32 v95, v50, 2, v13
    v_cmp_gt_u32 vcc, 64, v9
    s_waitcnt vmcnt(7)
    ds_write_b128 v14, v[40:43] offset:35072
    s_and_saveexec_b64 s[26:27], vcc
    ds_write_b128 v14, v[44:47] offset:37120
    s_mov_b64 exec, s[26:27]
    v_cmp_le_u32 vcc, 2, v9
    v_cmp_le_u32 s[26:27], 1, v9
    s_waitcnt lgkmcnt(0)
    s_barrier
    ds_read_b32 v48, v80 offset:35072
    ds_read_b32 v49, v81 offset:35072
    ds_read_b32 v50, v82 offset:35072
    ds_read_b32 v51, v83 offset:35072
    ds_read_b32 v52, v84 offset:35072
    ds_read_b32 v53, v85 offset:35072
    ds_read_b32 v54, v86 offset:35072
    ds_read_b32 v55, v87 offset:35072
    ds_read_b32 v56, v88 offset:35072
    ds_read_b32 v57, v89 offset:35072
    ds_read_b32 v58, v90 offset:35072
    ds_read_b32 v59, v91 offset:35072
    ds_read_b32 v60, v92 offset:35072
    ds_read_b32 v61, v93 offset:35072
    ds_read_b32 v62, v94 offset:35072
    ds_read_b32 v63, v95 offset:35072
    s_waitcnt vmcnt(0)
    v_cndmask_b32 v16, 0, v16, vcc
    v_cndmask_b32 v17, 0, v17, vcc
    v_cndmask_b32 v18, 0, v18, vcc
    v_cndmask_b32 v19, 0, v19, vcc
    v_cndmask_b32 v20, 0, v20, s[26:27]
    ds_write_b128 v11, v[16:19] offset:0
    v_alignbit_b32 v64, v17, v16, 16
    v_alignbit_b32 v65, v18, v17, 16
    v_alignbit_b32 v66, v19, v18, 16
    v_alignbit_b32 v67, v20, v19, 16
    ds_write_b128 v11, v[64:67] offset:4160
    ds_write_b128 v11, v[24:27] offset:2048
    v_alignbit_b32 v68, v25, v24, 16
    v_alignbit_b32 v69, v26, v25, 16
    v_alignbit_b32 v70, v27, v26, 16
    v_alignbit_b32 v71, v28, v27, 16
    ds_write_b128 v11, v[68:71] offset:6208
    s_waitcnt lgkmcnt(4)
    v_cvt_pk_bf16_f32 v96, v48, v49
    v_lshlrev_b32 v40, 16, v96
    v_and_b32 v41, s30, v96
    v_sub_f32 v40, v48, v40
    v_sub_f32 v41, v49, v41
    v_cvt_pk_bf16_f32 v100, v40, v41
    v_cvt_pk_bf16_f32 v97, v50, v51
    v_lshlrev_b32 v40, 16, v97
    v_and_b32 v41, s30, v97
    v_sub_f32 v40, v50, v40
    v_sub_f32 v41, v51, v41
    v_cvt_pk_bf16_f32 v101, v40, v41
    v_cvt_pk_bf16_f32 v98, v52, v53
    v_lshlrev_b32 v40, 16, v98
    v_and_b32 v41, s30, v98
    v_sub_f32 v40, v52, v40
    v_sub_f32 v41, v53, v41
    v_cvt_pk_bf16_f32 v102, v40, v41
    v_cvt_pk_bf16_f32 v99, v54, v55
    v_lshlrev_b32 v40, 16, v99
    v_and_b32 v41, s30, v99
    v_sub_f32 v40, v54, v40
    v_sub_f32 v41, v55, v41
    v_cvt_pk_bf16_f32 v103, v40, v41
    ds_write_b128 v11, v[96:99] offset:8320
    ds_write_b128 v11, v[100:103] offset:12928
    v_cvt_pk_bf16_f32 v104, v56, v57
    v_lshlrev_b32 v40, 16, v104
    v_and_b32 v41, s30, v104
    v_sub_f32 v40, v56, v40
    v_sub_f32 v41, v57, v41
    v_cvt_pk_bf16_f32 v108, v40, v41
    v_cvt_pk_bf16_f32 v105, v58, v59
    v_lshlrev_b32 v40, 16, v105
    v_and_b32 v41, s30, v105
    v_sub_f32 v40, v58, v40
    v_sub_f32 v41, v59, v41
    v_cvt_pk_bf16_f32 v109, v40, v41
    v_cvt_pk_bf16_f32 v106, v60, v61
    v_lshlrev_b32 v40, 16, v106
    v_and_b32 v41, s30, v106
    v_sub_f32 v40, v60, v40
    v_sub_f32 v41, v61, v41
    v_cvt_pk_bf16_f32 v110, v40, v41
    v_cvt_pk_bf16_f32 v107, v62, v63
    v_lshlrev_b32 v40, 16, v107
    v_and_b32 v41, s30, v107
    v_sub_f32 v40, v62, v40
    v_sub_f32 v41, v63, v41
    v_cvt_pk_bf16_f32 v111, v40, v41
    ds_write_b128 v11, v[104:107] offset:10368
    ds_write_b128 v11, v[108:111] offset:14976
    v_cmp_gt_u32 vcc, 32, v9
    s_and_saveexec_b64 s[26:27], vcc
    v_mov_b32 v112, 0
    v_mov_b32 v113, 0
    v_mov_b32 v114, 0
    v_mov_b32 v115, 0
    ds_write_b128 v11, v[112:115] offset:12416
    ds_write_b128 v11, v[112:115] offset:17024
    v_cmp_gt_u32 vcc, 2, v9
    s_and_b64 exec, exec, vcc
    ds_write_b128 v11, v[32:35] offset:4096
    v_alignbit_b32 v72, v33, v32, 16
    v_alignbit_b32 v73, v34, v33, 16
    v_alignbit_b32 v74, v35, v34, 16
    v_alignbit_b32 v75, v36, v35, 16
    ds_write_b128 v11, v[72:75] offset:8256
    s_mov_b64 exec, s[26:27]
    v_and_b32 v1, 15, v0
    v_bfe_u32 v2, v0, 4, 2
    v_bfe_u32 v3, v0, 6, 1
    v_add_u32 v4, 1, v1
    v_and_b32 v7, 1, v4
    v_mul_u32_u24 v7, 4160, v7
    v_lshrrev_b32 v4, 1, v4
    v_lshl_add_u32 v4, v2, 2, v4
    v_lshl_add_u32 v4, v3, 6, v4
    v_lshl_add_u32 v4, v4, 2, v7
    v_add_u32 v4, v4, v10
    v_add_u32 v12, 1024, v4
    v_add_u32 v13, 2048, v4
    v_add_u32 v14, 3072, v4
    v_lshlrev_b32 v7, 5, v1
    v_sub_u32 v7, 8800, v7
    v_lshl_add_u32 v7, v2, 4, v7
    v_lshl_add_u32 v7, v3, 8, v7
    v_add_u32 v7, v7, v10
    v_mov_b32 v16, 0
    v_mov_b32 v17, 0
    v_mov_b32 v18, 0
    v_mov_b32 v19, 0
    v_mov_b32 v20, 0
    v_mov_b32 v21, 0
    v_mov_b32 v22, 0
    v_mov_b32 v23, 0
    v_mov_b32 v24, 0
    v_mov_b32 v25, 0
    v_mov_b32 v26, 0
    v_mov_b32 v27, 0
    v_mov_b32 v28, 0
    v_mov_b32 v29, 0
    v_mov_b32 v30, 0
    v_mov_b32 v31, 0
    v_mov_b32 v32, 0
    v_mov_b32 v33, 0
    v_mov_b32 v34, 0
    v_mov_b32 v35, 0
    v_mov_b32 v36, 0
    v_mov_b32 v37, 0
    v_mov_b32 v38, 0
    v_mov_b32 v39, 0
    v_mov_b32 v40, 0
    v_mov_b32 v41, 0
    v_mov_b32 v42, 0
    v_mov_b32 v43, 0
    v_mov_b32 v44, 0
    v_mov_b32 v45, 0
    v_mov_b32 v46, 0
    v_mov_b32 v47, 0
    s_waitcnt lgkmcnt(0)
    s_barrier
    ds_read_b128 v[80:83], v7 offset:3584
    ds_read_b128 v[84:87], v7 offset:3072
    ds_read_b128 v[88:91], v7 offset:2560
    ds_read_b128 v[92:95], v7 offset:2048
    ds_read_b128 v[96:99], v7 offset:1536
    ds_read_b128 v[100:103], v7 offset:1024
    ds_read_b128 v[104:107], v7 offset:512
    ds_read_b128 v[108:111], v7 offset:0
    ds_read2_b32 v[48:49], v4 offset0:0 offset1:1
    ds_read2_b32 v[50:51], v4 offset0:2 offset1:3
    ds_read2_b32 v[52:53], v4 offset0:128 offset1:129
    ds_read2_b32 v[54:55], v4 offset0:130 offset1:131
    ds_read2_b32 v[56:57], v12 offset0:0 offset1:1
    ds_read2_b32 v[58:59], v12 offset0:2 offset1:3
    ds_read2_b32 v[60:61], v12 offset0:128 offset1:129
    ds_read2_b32 v[62:63], v12 offset0:130 offset1:131
    ds_read2_b32 v[64:65], v13 offset0:0 offset1:1
    ds_read2_b32 v[66:67], v13 offset0:2 offset1:3
    ds_read2_b32 v[68:69], v13 offset0:128 offset1:129
    ds_read2_b32 v[70:71], v13 offset0:130 offset1:131
    ds_read2_b32 v[72:73], v14 offset0:0 offset1:1
    ds_read2_b32 v[74:75], v14 offset0:2 offset1:3
    ds_read2_b32 v[76:77], v14 offset0:128 offset1:129
    ds_read2_b32 v[78:79], v14 offset0:130 offset1:131
    ds_read_b128 v[112:115], v7 offset:8192
    ds_read_b128 v[116:119], v7 offset:7680
    ds_read_b128 v[120:123], v7 offset:7168
    ds_read_b128 v[124:127], v7 offset:6656
    ds_read_b128 v[128:131], v7 offset:6144
    ds_read_b128 v[132:135], v7 offset:5632
    ds_read_b128 v[136:139], v7 offset:5120
    ds_read_b128 v[140:143], v7 offset:4608
    s_waitcnt lgkmcnt(0)
    v_mfma_f32_16x16x32_bf16 v[16:19], v[48:51], v[80:83], v[16:19]
    ds_read_b128 v[176:179], v7 offset:3648
    v_mfma_f32_16x16x32_bf16 v[20:23], v[48:51], v[84:87], v[20:23]
    ds_read_b128 v[180:183], v7 offset:3136
    v_mfma_f32_16x16x32_bf16 v[24:27], v[48:51], v[88:91], v[24:27]
    ds_read_b128 v[184:187], v7 offset:2624
    v_mfma_f32_16x16x32_bf16 v[28:31], v[48:51], v[92:95], v[28:31]
    ds_read_b128 v[188:191], v7 offset:2112
    v_mfma_f32_16x16x32_bf16 v[32:35], v[48:51], v[96:99], v[32:35]
    ds_read_b128 v[192:195], v7 offset:1600
    v_mfma_f32_16x16x32_bf16 v[36:39], v[48:51], v[100:103], v[36:39]
    ds_read_b128 v[196:199], v7 offset:1088
    v_mfma_f32_16x16x32_bf16 v[40:43], v[48:51], v[104:107], v[40:43]
    ds_read_b128 v[200:203], v7 offset:576
    v_mfma_f32_16x16x32_bf16 v[44:47], v[48:51], v[108:111], v[44:47]
    ds_read_b128 v[204:207], v7 offset:64
    v_mfma_f32_16x16x32_bf16 v[16:19], v[48:51], v[112:115], v[16:19]
    ds_read2_b32 v[144:145], v4 offset0:16 offset1:17
    v_mfma_f32_16x16x32_bf16 v[20:23], v[48:51], v[116:119], v[20:23]
    ds_read2_b32 v[146:147], v4 offset0:18 offset1:19
    v_mfma_f32_16x16x32_bf16 v[24:27], v[48:51], v[120:123], v[24:27]
    ds_read2_b32 v[148:149], v4 offset0:144 offset1:145
    v_mfma_f32_16x16x32_bf16 v[28:31], v[48:51], v[124:127], v[28:31]
    ds_read2_b32 v[150:151], v4 offset0:146 offset1:147
    v_mfma_f32_16x16x32_bf16 v[32:35], v[48:51], v[128:131], v[32:35]
    ds_read2_b32 v[152:153], v12 offset0:16 offset1:17
    v_mfma_f32_16x16x32_bf16 v[36:39], v[48:51], v[132:135], v[36:39]
    ds_read2_b32 v[154:155], v12 offset0:18 offset1:19
    v_mfma_f32_16x16x32_bf16 v[40:43], v[48:51], v[136:139], v[40:43]
    ds_read2_b32 v[156:157], v12 offset0:144 offset1:145
    v_mfma_f32_16x16x32_bf16 v[44:47], v[48:51], v[140:143], v[44:47]
    ds_read2_b32 v[158:159], v12 offset0:146 offset1:147
    v_mfma_f32_16x16x32_bf16 v[20:23], v[52:55], v[80:83], v[20:23]
    ds_read2_b32 v[160:161], v13 offset0:16 offset1:17
    v_mfma_f32_16x16x32_bf16 v[24:27], v[52:55], v[84:87], v[24:27]
    ds_read2_b32 v[162:163], v13 offset0:18 offset1:19
    v_mfma_f32_16x16x32_bf16 v[28:31], v[52:55], v[88:91], v[28:31]
    ds_read2_b32 v[164:165], v13 offset0:144 offset1:145
    v_mfma_f32_16x16x32_bf16 v[32:35], v[52:55], v[92:95], v[32:35]
    ds_read2_b32 v[166:167], v13 offset0:146 offset1:147
    v_mfma_f32_16x16x32_bf16 v[36:39], v[52:55], v[96:99], v[36:39]
    ds_read2_b32 v[168:169], v14 offset0:16 offset1:17
    v_mfma_f32_16x16x32_bf16 v[40:43], v[52:55], v[100:103], v[40:43]
    ds_read2_b32 v[170:171], v14 offset0:18 offset1:19
    v_mfma_f32_16x16x32_bf16 v[44:47], v[52:55], v[104:107], v[44:47]
    ds_read2_b32 v[172:173], v14 offset0:144 offset1:145
    v_mfma_f32_16x16x32_bf16 v[20:23], v[52:55], v[112:115], v[20:23]
    ds_read2_b32 v[174:175], v14 offset0:146 offset1:147
    v_mfma_f32_16x16x32_bf16 v[24:27], v[52:55], v[116:119], v[24:27]
    ds_read_b128 v[208:211], v7 offset:8256
    v_mfma_f32_16x16x32_bf16 v[28:31], v[52:55], v[120:123], v[28:31]
    ds_read_b128 v[212:215], v7 offset:7744
    v_mfma_f32_16x16x32_bf16 v[32:35], v[52:55], v[124:127], v[32:35]
    ds_read_b128 v[216:219], v7 offset:7232
    v_mfma_f32_16x16x32_bf16 v[36:39], v[52:55], v[128:131], v[36:39]
    ds_read_b128 v[220:223], v7 offset:6720
    v_mfma_f32_16x16x32_bf16 v[40:43], v[52:55], v[132:135], v[40:43]
    ds_read_b128 v[224:227], v7 offset:6208
    v_mfma_f32_16x16x32_bf16 v[44:47], v[52:55], v[136:139], v[44:47]
    ds_read_b128 v[228:231], v7 offset:5696
    v_mfma_f32_16x16x32_bf16 v[24:27], v[56:59], v[80:83], v[24:27]
    ds_read_b128 v[232:235], v7 offset:5184
    v_mfma_f32_16x16x32_bf16 v[28:31], v[56:59], v[84:87], v[28:31]
    ds_read_b128 v[236:239], v7 offset:4672
    v_mfma_f32_16x16x32_bf16 v[32:35], v[56:59], v[88:91], v[32:35]
    v_mfma_f32_16x16x32_bf16 v[36:39], v[56:59], v[92:95], v[36:39]
    v_mfma_f32_16x16x32_bf16 v[40:43], v[56:59], v[96:99], v[40:43]
    v_mfma_f32_16x16x32_bf16 v[44:47], v[56:59], v[100:103], v[44:47]
    v_mfma_f32_16x16x32_bf16 v[24:27], v[56:59], v[112:115], v[24:27]
    v_mfma_f32_16x16x32_bf16 v[28:31], v[56:59], v[116:119], v[28:31]
    v_mfma_f32_16x16x32_bf16 v[32:35], v[56:59], v[120:123], v[32:35]
    v_mfma_f32_16x16x32_bf16 v[36:39], v[56:59], v[124:127], v[36:39]
    v_mfma_f32_16x16x32_bf16 v[40:43], v[56:59], v[128:131], v[40:43]
    v_mfma_f32_16x16x32_bf16 v[44:47], v[56:59], v[132:135], v[44:47]
    v_mfma_f32_16x16x32_bf16 v[28:31], v[60:63], v[80:83], v[28:31]
    v_mfma_f32_16x16x32_bf16 v[32:35], v[60:63], v[84:87], v[32:35]
    v_mfma_f32_16x16x32_bf16 v[36:39], v[60:63], v[88:91], v[36:39]
    v_mfma_f32_16x16x32_bf16 v[40:43], v[60:63], v[92:95], v[40:43]
    v_mfma_f32_16x16x32_bf16 v[44:47], v[60:63], v[96:99], v[44:47]
    v_mfma_f32_16x16x32_bf16 v[28:31], v[60:63], v[112:115], v[28:31]
    v_mfma_f32_16x16x32_bf16 v[32:35], v[60:63], v[116:119], v[32:35]
    v_mfma_f32_16x16x32_bf16 v[36:39], v[60:63], v[120:123], v[36:39]
    v_mfma_f32_16x16x32_bf16 v[40:43], v[60:63], v[124:127], v[40:43]
    v_mfma_f32_16x16x32_bf16 v[44:47], v[60:63], v[128:131], v[44:47]
    v_mfma_f32_16x16x32_bf16 v[32:35], v[64:67], v[80:83], v[32:35]
    v_mfma_f32_16x16x32_bf16 v[36:39], v[64:67], v[84:87], v[36:39]
    v_mfma_f32_16x16x32_bf16 v[40:43], v[64:67], v[88:91], v[40:43]
    v_mfma_f32_16x16x32_bf16 v[44:47], v[64:67], v[92:95], v[44:47]
    v_mfma_f32_16x16x32_bf16 v[32:35], v[64:67], v[112:115], v[32:35]
    v_mfma_f32_16x16x32_bf16 v[36:39], v[64:67], v[116:119], v[36:39]
    v_mfma_f32_16x16x32_bf16 v[40:43], v[64:67], v[120:123], v[40:43]
    v_mfma_f32_16x16x32_bf16 v[44:47], v[64:67], v[124:127], v[44:47]
    v_mfma_f32_16x16x32_bf16 v[36:39], v[68:71], v[80:83], v[36:39]
    v_mfma_f32_16x16x32_bf16 v[40:43], v[68:71], v[84:87], v[40:43]
    v_mfma_f32_16x16x32_bf16 v[44:47], v[68:71], v[88:91], v[44:47]
    v_mfma_f32_16x16x32_bf16 v[36:39], v[68:71], v[112:115], v[36:39]
    v_mfma_f32_16x16x32_bf16 v[40:43], v[68:71], v[116:119], v[40:43]
    v_mfma_f32_16x16x32_bf16 v[44:47], v[68:71], v[120:123], v[44:47]
    v_mfma_f32_16x16x32_bf16 v[40:43], v[72:75], v[80:83], v[40:43]
    v_mfma_f32_16x16x32_bf16 v[44:47], v[72:75], v[84:87], v[44:47]
    v_mfma_f32_16x16x32_bf16 v[40:43], v[72:75], v[112:115], v[40:43]
    v_mfma_f32_16x16x32_bf16 v[44:47], v[72:75], v[116:119], v[44:47]
    v_mfma_f32_16x16x32_bf16 v[44:47], v[76:79], v[80:83], v[44:47]
    v_mfma_f32_16x16x32_bf16 v[44:47], v[76:79], v[112:115], v[44:47]
    s_waitcnt lgkmcnt(0)
    v_mfma_f32_16x16x32_bf16 v[16:19], v[144:147], v[176:179], v[16:19]
    ds_read_b128 v[80:83], v7 offset:3712
    v_mfma_f32_16x16x32_bf16 v[20:23], v[144:147], v[180:183], v[20:23]
    ds_read_b128 v[84:87], v7 offset:3200
    v_mfma_f32_16x16x32_bf16 v[24:27], v[144:147], v[184:187], v[24:27]
    ds_read_b128 v[88:91], v7 offset:2688
    v_mfma_f32_16x16x32_bf16 v[28:31], v[144:147], v[188:191], v[28:31]
    ds_read_b128 v[92:95], v7 offset:2176
    v_mfma_f32_16x16x32_bf16 v[32:35], v[144:147], v[192:195], v[32:35]
    ds_read_b128 v[96:99], v7 offset:1664
    v_mfma_f32_16x16x32_bf16 v[36:39], v[144:147], v[196:199], v[36:39]
    ds_read_b128 v[100:103], v7 offset:1152
    v_mfma_f32_16x16x32_bf16 v[40:43], v[144:147], v[200:203], v[40:43]
    ds_read_b128 v[104:107], v7 offset:640
    v_mfma_f32_16x16x32_bf16 v[44:47], v[144:147], v[204:207], v[44:47]
    ds_read_b128 v[108:111], v7 offset:128
    v_mfma_f32_16x16x32_bf16 v[16:19], v[144:147], v[208:211], v[16:19]
    ds_read2_b32 v[48:49], v4 offset0:32 offset1:33
    v_mfma_f32_16x16x32_bf16 v[20:23], v[144:147], v[212:215], v[20:23]
    ds_read2_b32 v[50:51], v4 offset0:34 offset1:35
    v_mfma_f32_16x16x32_bf16 v[24:27], v[144:147], v[216:219], v[24:27]
    ds_read2_b32 v[52:53], v4 offset0:160 offset1:161
    v_mfma_f32_16x16x32_bf16 v[28:31], v[144:147], v[220:223], v[28:31]
    ds_read2_b32 v[54:55], v4 offset0:162 offset1:163
    v_mfma_f32_16x16x32_bf16 v[32:35], v[144:147], v[224:227], v[32:35]
    ds_read2_b32 v[56:57], v12 offset0:32 offset1:33
    v_mfma_f32_16x16x32_bf16 v[36:39], v[144:147], v[228:231], v[36:39]
    ds_read2_b32 v[58:59], v12 offset0:34 offset1:35
    v_mfma_f32_16x16x32_bf16 v[40:43], v[144:147], v[232:235], v[40:43]
    ds_read2_b32 v[60:61], v12 offset0:160 offset1:161
    v_mfma_f32_16x16x32_bf16 v[44:47], v[144:147], v[236:239], v[44:47]
    ds_read2_b32 v[62:63], v12 offset0:162 offset1:163
    v_mfma_f32_16x16x32_bf16 v[20:23], v[148:151], v[176:179], v[20:23]
    ds_read2_b32 v[64:65], v13 offset0:32 offset1:33
    v_mfma_f32_16x16x32_bf16 v[24:27], v[148:151], v[180:183], v[24:27]
    ds_read2_b32 v[66:67], v13 offset0:34 offset1:35
    v_mfma_f32_16x16x32_bf16 v[28:31], v[148:151], v[184:187], v[28:31]
    ds_read2_b32 v[68:69], v13 offset0:160 offset1:161
    v_mfma_f32_16x16x32_bf16 v[32:35], v[148:151], v[188:191], v[32:35]
    ds_read2_b32 v[70:71], v13 offset0:162 offset1:163
    v_mfma_f32_16x16x32_bf16 v[36:39], v[148:151], v[192:195], v[36:39]
    ds_read2_b32 v[72:73], v14 offset0:32 offset1:33
    v_mfma_f32_16x16x32_bf16 v[40:43], v[148:151], v[196:199], v[40:43]
    ds_read2_b32 v[74:75], v14 offset0:34 offset1:35
    v_mfma_f32_16x16x32_bf16 v[44:47], v[148:151], v[200:203], v[44:47]
    ds_read2_b32 v[76:77], v14 offset0:160 offset1:161
    v_mfma_f32_16x16x32_bf16 v[20:23], v[148:151], v[208:211], v[20:23]
    ds_read2_b32 v[78:79], v14 offset0:162 offset1:163
    v_mfma_f32_16x16x32_bf16 v[24:27], v[148:151], v[212:215], v[24:27]
    ds_read_b128 v[112:115], v7 offset:8320
    v_mfma_f32_16x16x32_bf16 v[28:31], v[148:151], v[216:219], v[28:31]
    ds_read_b128 v[116:119], v7 offset:7808
    v_mfma_f32_16x16x32_bf16 v[32:35], v[148:151], v[220:223], v[32:35]
    ds_read_b128 v[120:123], v7 offset:7296
    v_mfma_f32_16x16x32_bf16 v[36:39], v[148:151], v[224:227], v[36:39]
    ds_read_b128 v[124:127], v7 offset:6784
    v_mfma_f32_16x16x32_bf16 v[40:43], v[148:151], v[228:231], v[40:43]
    ds_read_b128 v[128:131], v7 offset:6272
    v_mfma_f32_16x16x32_bf16 v[44:47], v[148:151], v[232:235], v[44:47]
    ds_read_b128 v[132:135], v7 offset:5760
    v_mfma_f32_16x16x32_bf16 v[24:27], v[152:155], v[176:179], v[24:27]
    ds_read_b128 v[136:139], v7 offset:5248
    v_mfma_f32_16x16x32_bf16 v[28:31], v[152:155], v[180:183], v[28:31]
    ds_read_b128 v[140:143], v7 offset:4736
    v_mfma_f32_16x16x32_bf16 v[32:35], v[152:155], v[184:187], v[32:35]
    v_mfma_f32_16x16x32_bf16 v[36:39], v[152:155], v[188:191], v[36:39]
    v_mfma_f32_16x16x32_bf16 v[40:43], v[152:155], v[192:195], v[40:43]
    v_mfma_f32_16x16x32_bf16 v[44:47], v[152:155], v[196:199], v[44:47]
    v_mfma_f32_16x16x32_bf16 v[24:27], v[152:155], v[208:211], v[24:27]
    v_mfma_f32_16x16x32_bf16 v[28:31], v[152:155], v[212:215], v[28:31]
    v_mfma_f32_16x16x32_bf16 v[32:35], v[152:155], v[216:219], v[32:35]
    v_mfma_f32_16x16x32_bf16 v[36:39], v[152:155], v[220:223], v[36:39]
    v_mfma_f32_16x16x32_bf16 v[40:43], v[152:155], v[224:227], v[40:43]
    v_mfma_f32_16x16x32_bf16 v[44:47], v[152:155], v[228:231], v[44:47]
    v_mfma_f32_16x16x32_bf16 v[28:31], v[156:159], v[176:179], v[28:31]
    v_mfma_f32_16x16x32_bf16 v[32:35], v[156:159], v[180:183], v[32:35]
    v_mfma_f32_16x16x32_bf16 v[36:39], v[156:159], v[184:187], v[36:39]
    v_mfma_f32_16x16x32_bf16 v[40:43], v[156:159], v[188:191], v[40:43]
    v_mfma_f32_16x16x32_bf16 v[44:47], v[156:159], v[192:195], v[44:47]
    v_mfma_f32_16x16x32_bf16 v[28:31], v[156:159], v[208:211], v[28:31]
    v_mfma_f32_16x16x32_bf16 v[32:35], v[156:159], v[212:215], v[32:35]
    v_mfma_f32_16x16x32_bf16 v[36:39], v[156:159], v[216:219], v[36:39]
    v_mfma_f32_16x16x32_bf16 v[40:43], v[156:159], v[220:223], v[40:43]
    v_mfma_f32_16x16x32_bf16 v[44:47], v[156:159], v[224:227], v[44:47]
    v_mfma_f32_16x16x32_bf16 v[32:35], v[160:163], v[176:179], v[32:35]
    v_mfma_f32_16x16x32_bf16 v[36:39], v[160:163], v[180:183], v[36:39]
    v_mfma_f32_16x16x32_bf16 v[40:43], v[160:163], v[184:187], v[40:43]
    v_mfma_f32_16x16x32_bf16 v[44:47], v[160:163], v[188:191], v[44:47]
    v_mfma_f32_16x16x32_bf16 v[32:35], v[160:163], v[208:211], v[32:35]
    v_mfma_f32_16x16x32_bf16 v[36:39], v[160:163], v[212:215], v[36:39]
    v_mfma_f32_16x16x32_bf16 v[40:43], v[160:163], v[216:219], v[40:43]
    v_mfma_f32_16x16x32_bf16 v[44:47], v[160:163], v[220:223], v[44:47]
    v_mfma_f32_16x16x32_bf16 v[36:39], v[164:167], v[176:179], v[36:39]
    v_mfma_f32_16x16x32_bf16 v[40:43], v[164:167], v[180:183], v[40:43]
    v_mfma_f32_16x16x32_bf16 v[44:47], v[164:167], v[184:187], v[44:47]
    v_mfma_f32_16x16x32_bf16 v[36:39], v[164:167], v[208:211], v[36:39]
    v_mfma_f32_16x16x32_bf16 v[40:43], v[164:167], v[212:215], v[40:43]
    v_mfma_f32_16x16x32_bf16 v[44:47], v[164:167], v[216:219], v[44:47]
    v_mfma_f32_16x16x32_bf16 v[40:43], v[168:171], v[176:179], v[40:43]
    v_mfma_f32_16x16x32_bf16 v[44:47], v[168:171], v[180:183], v[44:47]
    v_mfma_f32_16x16x32_bf16 v[40:43], v[168:171], v[208:211], v[40:43]
    v_mfma_f32_16x16x32_bf16 v[44:47], v[168:171], v[212:215], v[44:47]
    v_mfma_f32_16x16x32_bf16 v[44:47], v[172:175], v[176:179], v[44:47]
    v_mfma_f32_16x16x32_bf16 v[44:47], v[172:175], v[208:211], v[44:47]
    s_waitcnt lgkmcnt(0)
    v_mfma_f32_16x16x32_bf16 v[16:19], v[48:51], v[80:83], v[16:19]
    ds_read_b128 v[176:179], v7 offset:3776
    v_mfma_f32_16x16x32_bf16 v[20:23], v[48:51], v[84:87], v[20:23]
    ds_read_b128 v[180:183], v7 offset:3264
    v_mfma_f32_16x16x32_bf16 v[24:27], v[48:51], v[88:91], v[24:27]
    ds_read_b128 v[184:187], v7 offset:2752
    v_mfma_f32_16x16x32_bf16 v[28:31], v[48:51], v[92:95], v[28:31]
    ds_read_b128 v[188:191], v7 offset:2240
    v_mfma_f32_16x16x32_bf16 v[32:35], v[48:51], v[96:99], v[32:35]
    ds_read_b128 v[192:195], v7 offset:1728
    v_mfma_f32_16x16x32_bf16 v[36:39], v[48:51], v[100:103], v[36:39]
    ds_read_b128 v[196:199], v7 offset:1216
    v_mfma_f32_16x16x32_bf16 v[40:43], v[48:51], v[104:107], v[40:43]
    ds_read_b128 v[200:203], v7 offset:704
    v_mfma_f32_16x16x32_bf16 v[44:47], v[48:51], v[108:111], v[44:47]
    ds_read_b128 v[204:207], v7 offset:192
    v_mfma_f32_16x16x32_bf16 v[16:19], v[48:51], v[112:115], v[16:19]
    ds_read2_b32 v[144:145], v4 offset0:48 offset1:49
    v_mfma_f32_16x16x32_bf16 v[20:23], v[48:51], v[116:119], v[20:23]
    ds_read2_b32 v[146:147], v4 offset0:50 offset1:51
    v_mfma_f32_16x16x32_bf16 v[24:27], v[48:51], v[120:123], v[24:27]
    ds_read2_b32 v[148:149], v4 offset0:176 offset1:177
    v_mfma_f32_16x16x32_bf16 v[28:31], v[48:51], v[124:127], v[28:31]
    ds_read2_b32 v[150:151], v4 offset0:178 offset1:179
    v_mfma_f32_16x16x32_bf16 v[32:35], v[48:51], v[128:131], v[32:35]
    ds_read2_b32 v[152:153], v12 offset0:48 offset1:49
    v_mfma_f32_16x16x32_bf16 v[36:39], v[48:51], v[132:135], v[36:39]
    ds_read2_b32 v[154:155], v12 offset0:50 offset1:51
    v_mfma_f32_16x16x32_bf16 v[40:43], v[48:51], v[136:139], v[40:43]
    ds_read2_b32 v[156:157], v12 offset0:176 offset1:177
    v_mfma_f32_16x16x32_bf16 v[44:47], v[48:51], v[140:143], v[44:47]
    ds_read2_b32 v[158:159], v12 offset0:178 offset1:179
    v_mfma_f32_16x16x32_bf16 v[20:23], v[52:55], v[80:83], v[20:23]
    ds_read2_b32 v[160:161], v13 offset0:48 offset1:49
    v_mfma_f32_16x16x32_bf16 v[24:27], v[52:55], v[84:87], v[24:27]
    ds_read2_b32 v[162:163], v13 offset0:50 offset1:51
    v_mfma_f32_16x16x32_bf16 v[28:31], v[52:55], v[88:91], v[28:31]
    ds_read2_b32 v[164:165], v13 offset0:176 offset1:177
    v_mfma_f32_16x16x32_bf16 v[32:35], v[52:55], v[92:95], v[32:35]
    ds_read2_b32 v[166:167], v13 offset0:178 offset1:179
    v_mfma_f32_16x16x32_bf16 v[36:39], v[52:55], v[96:99], v[36:39]
    ds_read2_b32 v[168:169], v14 offset0:48 offset1:49
    v_mfma_f32_16x16x32_bf16 v[40:43], v[52:55], v[100:103], v[40:43]
    ds_read2_b32 v[170:171], v14 offset0:50 offset1:51
    v_mfma_f32_16x16x32_bf16 v[44:47], v[52:55], v[104:107], v[44:47]
    ds_read2_b32 v[172:173], v14 offset0:176 offset1:177
    v_mfma_f32_16x16x32_bf16 v[20:23], v[52:55], v[112:115], v[20:23]
    ds_read2_b32 v[174:175], v14 offset0:178 offset1:179
    v_mfma_f32_16x16x32_bf16 v[24:27], v[52:55], v[116:119], v[24:27]
    ds_read_b128 v[208:211], v7 offset:8384
    v_mfma_f32_16x16x32_bf16 v[28:31], v[52:55], v[120:123], v[28:31]
    ds_read_b128 v[212:215], v7 offset:7872
    v_mfma_f32_16x16x32_bf16 v[32:35], v[52:55], v[124:127], v[32:35]
    ds_read_b128 v[216:219], v7 offset:7360
    v_mfma_f32_16x16x32_bf16 v[36:39], v[52:55], v[128:131], v[36:39]
    ds_read_b128 v[220:223], v7 offset:6848
    v_mfma_f32_16x16x32_bf16 v[40:43], v[52:55], v[132:135], v[40:43]
    ds_read_b128 v[224:227], v7 offset:6336
    v_mfma_f32_16x16x32_bf16 v[44:47], v[52:55], v[136:139], v[44:47]
    ds_read_b128 v[228:231], v7 offset:5824
    v_mfma_f32_16x16x32_bf16 v[24:27], v[56:59], v[80:83], v[24:27]
    ds_read_b128 v[232:235], v7 offset:5312
    v_mfma_f32_16x16x32_bf16 v[28:31], v[56:59], v[84:87], v[28:31]
    ds_read_b128 v[236:239], v7 offset:4800
    v_mfma_f32_16x16x32_bf16 v[32:35], v[56:59], v[88:91], v[32:35]
    v_mfma_f32_16x16x32_bf16 v[36:39], v[56:59], v[92:95], v[36:39]
    v_mfma_f32_16x16x32_bf16 v[40:43], v[56:59], v[96:99], v[40:43]
    v_mfma_f32_16x16x32_bf16 v[44:47], v[56:59], v[100:103], v[44:47]
    v_mfma_f32_16x16x32_bf16 v[24:27], v[56:59], v[112:115], v[24:27]
    v_mfma_f32_16x16x32_bf16 v[28:31], v[56:59], v[116:119], v[28:31]
    v_mfma_f32_16x16x32_bf16 v[32:35], v[56:59], v[120:123], v[32:35]
    v_mfma_f32_16x16x32_bf16 v[36:39], v[56:59], v[124:127], v[36:39]
    v_mfma_f32_16x16x32_bf16 v[40:43], v[56:59], v[128:131], v[40:43]
    v_mfma_f32_16x16x32_bf16 v[44:47], v[56:59], v[132:135], v[44:47]
    v_mfma_f32_16x16x32_bf16 v[28:31], v[60:63], v[80:83], v[28:31]
    v_mfma_f32_16x16x32_bf16 v[32:35], v[60:63], v[84:87], v[32:35]
    v_mfma_f32_16x16x32_bf16 v[36:39], v[60:63], v[88:91], v[36:39]
    v_mfma_f32_16x16x32_bf16 v[40:43], v[60:63], v[92:95], v[40:43]
    v_mfma_f32_16x16x32_bf16 v[44:47], v[60:63], v[96:99], v[44:47]
    v_mfma_f32_16x16x32_bf16 v[28:31], v[60:63], v[112:115], v[28:31]
    v_mfma_f32_16x16x32_bf16 v[32:35], v[60:63], v[116:119], v[32:35]
    v_mfma_f32_16x16x32_bf16 v[36:39], v[60:63], v[120:123], v[36:39]
    v_mfma_f32_16x16x32_bf16 v[40:43], v[60:63], v[124:127], v[40:43]
    v_mfma_f32_16x16x32_bf16 v[44:47], v[60:63], v[128:131], v[44:47]
    v_mfma_f32_16x16x32_bf16 v[32:35], v[64:67], v[80:83], v[32:35]
    v_mfma_f32_16x16x32_bf16 v[36:39], v[64:67], v[84:87], v[36:39]
    v_mfma_f32_16x16x32_bf16 v[40:43], v[64:67], v[88:91], v[40:43]
    v_mfma_f32_16x16x32_bf16 v[44:47], v[64:67], v[92:95], v[44:47]
    v_mfma_f32_16x16x32_bf16 v[32:35], v[64:67], v[112:115], v[32:35]
    v_mfma_f32_16x16x32_bf16 v[36:39], v[64:67], v[116:119], v[36:39]
    v_mfma_f32_16x16x32_bf16 v[40:43], v[64:67], v[120:123], v[40:43]
    v_mfma_f32_16x16x32_bf16 v[44:47], v[64:67], v[124:127], v[44:47]
    v_mfma_f32_16x16x32_bf16 v[36:39], v[68:71], v[80:83], v[36:39]
    v_mfma_f32_16x16x32_bf16 v[40:43], v[68:71], v[84:87], v[40:43]
    v_mfma_f32_16x16x32_bf16 v[44:47], v[68:71], v[88:91], v[44:47]
    v_mfma_f32_16x16x32_bf16 v[36:39], v[68:71], v[112:115], v[36:39]
    v_mfma_f32_16x16x32_bf16 v[40:43], v[68:71], v[116:119], v[40:43]
    v_mfma_f32_16x16x32_bf16 v[44:47], v[68:71], v[120:123], v[44:47]
    v_mfma_f32_16x16x32_bf16 v[40:43], v[72:75], v[80:83], v[40:43]
    v_mfma_f32_16x16x32_bf16 v[44:47], v[72:75], v[84:87], v[44:47]
    v_mfma_f32_16x16x32_bf16 v[40:43], v[72:75], v[112:115], v[40:43]
    v_mfma_f32_16x16x32_bf16 v[44:47], v[72:75], v[116:119], v[44:47]
    v_mfma_f32_16x16x32_bf16 v[44:47], v[76:79], v[80:83], v[44:47]
    v_mfma_f32_16x16x32_bf16 v[44:47], v[76:79], v[112:115], v[44:47]
    s_waitcnt lgkmcnt(0)
    v_mfma_f32_16x16x32_bf16 v[16:19], v[144:147], v[176:179], v[16:19]
    v_mfma_f32_16x16x32_bf16 v[20:23], v[144:147], v[180:183], v[20:23]
    v_mfma_f32_16x16x32_bf16 v[24:27], v[144:147], v[184:187], v[24:27]
    v_mfma_f32_16x16x32_bf16 v[28:31], v[144:147], v[188:191], v[28:31]
    v_mfma_f32_16x16x32_bf16 v[32:35], v[144:147], v[192:195], v[32:35]
    v_mfma_f32_16x16x32_bf16 v[36:39], v[144:147], v[196:199], v[36:39]
    v_mfma_f32_16x16x32_bf16 v[40:43], v[144:147], v[200:203], v[40:43]
    v_mfma_f32_16x16x32_bf16 v[44:47], v[144:147], v[204:207], v[44:47]
    v_mfma_f32_16x16x32_bf16 v[16:19], v[144:147], v[208:211], v[16:19]
    v_mfma_f32_16x16x32_bf16 v[20:23], v[144:147], v[212:215], v[20:23]
    v_mfma_f32_16x16x32_bf16 v[24:27], v[144:147], v[216:219], v[24:27]
    v_mfma_f32_16x16x32_bf16 v[28:31], v[144:147], v[220:223], v[28:31]
    v_mfma_f32_16x16x32_bf16 v[32:35], v[144:147], v[224:227], v[32:35]
    v_mfma_f32_16x16x32_bf16 v[36:39], v[144:147], v[228:231], v[36:39]
    v_mfma_f32_16x16x32_bf16 v[40:43], v[144:147], v[232:235], v[40:43]
    v_mfma_f32_16x16x32_bf16 v[44:47], v[144:147], v[236:239], v[44:47]
    v_mfma_f32_16x16x32_bf16 v[20:23], v[148:151], v[176:179], v[20:23]
    v_mfma_f32_16x16x32_bf16 v[24:27], v[148:151], v[180:183], v[24:27]
    v_mfma_f32_16x16x32_bf16 v[28:31], v[148:151], v[184:187], v[28:31]
    v_mfma_f32_16x16x32_bf16 v[32:35], v[148:151], v[188:191], v[32:35]
    v_mfma_f32_16x16x32_bf16 v[36:39], v[148:151], v[192:195], v[36:39]
    v_mfma_f32_16x16x32_bf16 v[40:43], v[148:151], v[196:199], v[40:43]
    v_mfma_f32_16x16x32_bf16 v[44:47], v[148:151], v[200:203], v[44:47]
    v_mfma_f32_16x16x32_bf16 v[20:23], v[148:151], v[208:211], v[20:23]
    v_mfma_f32_16x16x32_bf16 v[24:27], v[148:151], v[212:215], v[24:27]
    v_mfma_f32_16x16x32_bf16 v[28:31], v[148:151], v[216:219], v[28:31]
    v_mfma_f32_16x16x32_bf16 v[32:35], v[148:151], v[220:223], v[32:35]
    v_mfma_f32_16x16x32_bf16 v[36:39], v[148:151], v[224:227], v[36:39]
    v_mfma_f32_16x16x32_bf16 v[40:43], v[148:151], v[228:231], v[40:43]
    v_mfma_f32_16x16x32_bf16 v[44:47], v[148:151], v[232:235], v[44:47]
    v_mfma_f32_16x16x32_bf16 v[24:27], v[152:155], v[176:179], v[24:27]
    v_mfma_f32_16x16x32_bf16 v[28:31], v[152:155], v[180:183], v[28:31]
    v_mfma_f32_16x16x32_bf16 v[32:35], v[152:155], v[184:187], v[32:35]
    v_mfma_f32_16x16x32_bf16 v[36:39], v[152:155], v[188:191], v[36:39]
    v_mfma_f32_16x16x32_bf16 v[40:43], v[152:155], v[192:195], v[40:43]
    v_mfma_f32_16x16x32_bf16 v[44:47], v[152:155], v[196:199], v[44:47]
    v_mfma_f32_16x16x32_bf16 v[24:27], v[152:155], v[208:211], v[24:27]
    v_mfma_f32_16x16x32_bf16 v[28:31], v[152:155], v[212:215], v[28:31]
    v_mfma_f32_16x16x32_bf16 v[32:35], v[152:155], v[216:219], v[32:35]
    v_mfma_f32_16x16x32_bf16 v[36:39], v[152:155], v[220:223], v[36:39]
    v_mfma_f32_16x16x32_bf16 v[40:43], v[152:155], v[224:227], v[40:43]
    v_mfma_f32_16x16x32_bf16 v[44:47], v[152:155], v[228:231], v[44:47]
    v_mfma_f32_16x16x32_bf16 v[28:31], v[156:159], v[176:179], v[28:31]
    v_mfma_f32_16x16x32_bf16 v[32:35], v[156:159], v[180:183], v[32:35]
    v_mfma_f32_16x16x32_bf16 v[36:39], v[156:159], v[184:187], v[36:39]
    v_mfma_f32_16x16x32_bf16 v[40:43], v[156:159], v[188:191], v[40:43]
    v_mfma_f32_16x16x32_bf16 v[44:47], v[156:159], v[192:195], v[44:47]
    v_mfma_f32_16x16x32_bf16 v[28:31], v[156:159], v[208:211], v[28:31]
    v_mfma_f32_16x16x32_bf16 v[32:35], v[156:159], v[212:215], v[32:35]
    v_mfma_f32_16x16x32_bf16 v[36:39], v[156:159], v[216:219], v[36:39]
    v_mfma_f32_16x16x32_bf16 v[40:43], v[156:159], v[220:223], v[40:43]
    v_mfma_f32_16x16x32_bf16 v[44:47], v[156:159], v[224:227], v[44:47]
    v_mfma_f32_16x16x32_bf16 v[32:35], v[160:163], v[176:179], v[32:35]
    v_mfma_f32_16x16x32_bf16 v[36:39], v[160:163], v[180:183], v[36:39]
    v_mfma_f32_16x16x32_bf16 v[40:43], v[160:163], v[184:187], v[40:43]
    v_mfma_f32_16x16x32_bf16 v[44:47], v[160:163], v[188:191], v[44:47]
    v_mfma_f32_16x16x32_bf16 v[32:35], v[160:163], v[208:211], v[32:35]
    v_mfma_f32_16x16x32_bf16 v[36:39], v[160:163], v[212:215], v[36:39]
    v_mfma_f32_16x16x32_bf16 v[40:43], v[160:163], v[216:219], v[40:43]
    v_mfma_f32_16x16x32_bf16 v[44:47], v[160:163], v[220:223], v[44:47]
    v_mfma_f32_16x16x32_bf16 v[36:39], v[164:167], v[176:179], v[36:39]
    v_mfma_f32_16x16x32_bf16 v[40:43], v[164:167], v[180:183], v[40:43]
    v_mfma_f32_16x16x32_bf16 v[44:47], v[164:167], v[184:187], v[44:47]
    v_mfma_f32_16x16x32_bf16 v[36:39], v[164:167], v[208:211], v[36:39]
    v_mfma_f32_16x16x32_bf16 v[40:43], v[164:167], v[212:215], v[40:43]
    v_mfma_f32_16x16x32_bf16 v[44:47], v[164:167], v[216:219], v[44:47]
    v_mfma_f32_16x16x32_bf16 v[40:43], v[168:171], v[176:179], v[40:43]
    v_mfma_f32_16x16x32_bf16 v[44:47], v[168:171], v[180:183], v[44:47]
    v_mfma_f32_16x16x32_bf16 v[40:43], v[168:171], v[208:211], v[40:43]
    v_mfma_f32_16x16x32_bf16 v[44:47], v[168:171], v[212:215], v[44:47]
    v_mfma_f32_16x16x32_bf16 v[44:47], v[172:175], v[176:179], v[44:47]
    v_mfma_f32_16x16x32_bf16 v[44:47], v[172:175], v[208:211], v[44:47]
    v_and_b32 v8, 63, v0
    v_lshrrev_b32 v9, 6, v0
    v_lshlrev_b32 v8, 4, v8
    v_lshl_add_u32 v11, v9, 12, v8
    v_xor_b32 v12, 4096, v11
    v_cmp_eq_u32 vcc, 0, v3
    s_nop 5
    v_cndmask_b32 v48, v32, v16, vcc
    v_cndmask_b32 v64, v16, v32, vcc
    v_cndmask_b32 v49, v33, v17, vcc
    v_cndmask_b32 v65, v17, v33, vcc
    v_cndmask_b32 v50, v34, v18, vcc
    v_cndmask_b32 v66, v18, v34, vcc
    v_cndmask_b32 v51, v35, v19, vcc
    v_cndmask_b32 v67, v19, v35, vcc
    v_cndmask_b32 v52, v36, v20, vcc
    v_cndmask_b32 v68, v20, v36, vcc
    v_cndmask_b32 v53, v37, v21, vcc
    v_cndmask_b32 v69, v21, v37, vcc
    v_cndmask_b32 v54, v38, v22, vcc
    v_cndmask_b32 v70, v22, v38, vcc
    v_cndmask_b32 v55, v39, v23, vcc
    v_cndmask_b32 v71, v23, v39, vcc
    v_cndmask_b32 v56, v40, v24, vcc
    v_cndmask_b32 v72, v24, v40, vcc
    v_cndmask_b32 v57, v41, v25, vcc
    v_cndmask_b32 v73, v25, v41, vcc
    v_cndmask_b32 v58, v42, v26, vcc
    v_cndmask_b32 v74, v26, v42, vcc
    v_cndmask_b32 v59, v43, v27, vcc
    v_cndmask_b32 v75, v27, v43, vcc
    v_cndmask_b32 v60, v44, v28, vcc
    v_cndmask_b32 v76, v28, v44, vcc
    v_cndmask_b32 v61, v45, v29, vcc
    v_cndmask_b32 v77, v29, v45, vcc
    v_cndmask_b32 v62, v46, v30, vcc
    v_cndmask_b32 v78, v30, v46, vcc
    v_cndmask_b32 v63, v47, v31, vcc
    v_cndmask_b32 v79, v31, v47, vcc
    ds_write_b128 v11, v[64:67] offset:35072
    ds_write_b128 v11, v[68:71] offset:36096
    ds_write_b128 v11, v[72:75] offset:37120
    ds_write_b128 v11, v[76:79] offset:38144
    v_lshlrev_b32 v13, 5, v1
    v_lshl_add_u32 v13, v2, 3, v13
    v_lshl_add_u32 v13, v3, 11, v13
    v_add_u32 v14, v13, v10
    ds_read_b64 v[96:97], v14 offset:32
    ds_read_b64 v[98:99], v14 offset:544
    ds_read_b64 v[100:101], v14 offset:1056
    ds_read_b64 v[102:103], v14 offset:1568
    s_waitcnt lgkmcnt(0)
    s_barrier
    ds_read_b128 v[64:67], v12 offset:35072
    ds_read_b128 v[68:71], v12 offset:36096
    ds_read_b128 v[72:75], v12 offset:37120
    ds_read_b128 v[76:79], v12 offset:38144
    s_mov_b32 s50, 0xffff0000
    v_lshlrev_b32 v6, 16, v6
    v_lshlrev_b32 v15, 5, v1
    v_lshl_add_u32 v15, v3, 11, v15
    v_lshl_add_u32 v15, v5, 12, v15
    v_and_b32 v13, 1, v2
    v_lshl_add_u32 v15, v13, 9, v15
    v_lshrrev_b32 v13, 1, v2
    v_lshl_add_u32 v15, v13, 4, v15
    s_mov_b32 s6, 10813440
    s_waitcnt lgkmcnt(0)
    v_add_f32 v48, v48, v64
    v_add_f32 v49, v49, v65
    v_add_f32 v50, v50, v66
    v_add_f32 v51, v51, v67
    v_cvt_pk_bf16_f32 v80, v48, v49
    v_lshlrev_b32 v48, 16, v80
    v_and_b32 v49, s50, v80
    v_lshlrev_b32 v81, 16, v96
    v_and_b32 v82, s50, v96
    v_mul_f32 v81, v81, v6
    v_mul_f32 v82, v82, v6
    v_cvt_pk_bf16_f32 v80, v81, v82
    v_lshlrev_b32 v81, 16, v80
    v_and_b32 v82, s50, v80
    v_add_f32 v81, v81, v48
    v_add_f32 v82, v82, v49
    v_cvt_pk_bf16_f32 v84, v81, v82
    v_cvt_pk_bf16_f32 v80, v50, v51
    v_lshlrev_b32 v50, 16, v80
    v_and_b32 v51, s50, v80
    v_lshlrev_b32 v81, 16, v97
    v_and_b32 v82, s50, v97
    v_mul_f32 v81, v81, v6
    v_mul_f32 v82, v82, v6
    v_cvt_pk_bf16_f32 v80, v81, v82
    v_lshlrev_b32 v81, 16, v80
    v_and_b32 v82, s50, v80
    v_add_f32 v81, v81, v50
    v_add_f32 v82, v82, v51
    v_cvt_pk_bf16_f32 v85, v81, v82
    v_add_f32 v52, v52, v68
    v_add_f32 v53, v53, v69
    v_add_f32 v54, v54, v70
    v_add_f32 v55, v55, v71
    v_cvt_pk_bf16_f32 v80, v52, v53
    v_lshlrev_b32 v52, 16, v80
    v_and_b32 v53, s50, v80
    v_lshlrev_b32 v81, 16, v98
    v_and_b32 v82, s50, v98
    v_mul_f32 v81, v81, v6
    v_mul_f32 v82, v82, v6
    v_cvt_pk_bf16_f32 v80, v81, v82
    v_lshlrev_b32 v81, 16, v80
    v_and_b32 v82, s50, v80
    v_add_f32 v81, v81, v52
    v_add_f32 v82, v82, v53
    v_cvt_pk_bf16_f32 v86, v81, v82
    v_cvt_pk_bf16_f32 v80, v54, v55
    v_lshlrev_b32 v54, 16, v80
    v_and_b32 v55, s50, v80
    v_lshlrev_b32 v81, 16, v99
    v_and_b32 v82, s50, v99
    v_mul_f32 v81, v81, v6
    v_mul_f32 v82, v82, v6
    v_cvt_pk_bf16_f32 v80, v81, v82
    v_lshlrev_b32 v81, 16, v80
    v_and_b32 v82, s50, v80
    v_add_f32 v81, v81, v54
    v_add_f32 v82, v82, v55
    v_cvt_pk_bf16_f32 v87, v81, v82
    s_nop 1
    v_permlane16_swap_b32 v84, v86
    v_permlane16_swap_b32 v85, v87
    buffer_store_dwordx4 v[84:87], v15, s[20:23], s6 offen offset:0 sc1
    v_add_f32 v56, v56, v72
    v_add_f32 v57, v57, v73
    v_add_f32 v58, v58, v74
    v_add_f32 v59, v59, v75
    v_cvt_pk_bf16_f32 v80, v56, v57
    v_lshlrev_b32 v56, 16, v80
    v_and_b32 v57, s50, v80
    v_lshlrev_b32 v81, 16, v100
    v_and_b32 v82, s50, v100
    v_mul_f32 v81, v81, v6
    v_mul_f32 v82, v82, v6
    v_cvt_pk_bf16_f32 v80, v81, v82
    v_lshlrev_b32 v81, 16, v80
    v_and_b32 v82, s50, v80
    v_add_f32 v81, v81, v56
    v_add_f32 v82, v82, v57
    v_cvt_pk_bf16_f32 v88, v81, v82
    v_cvt_pk_bf16_f32 v80, v58, v59
    v_lshlrev_b32 v58, 16, v80
    v_and_b32 v59, s50, v80
    v_lshlrev_b32 v81, 16, v101
    v_and_b32 v82, s50, v101
    v_mul_f32 v81, v81, v6
    v_mul_f32 v82, v82, v6
    v_cvt_pk_bf16_f32 v80, v81, v82
    v_lshlrev_b32 v81, 16, v80
    v_and_b32 v82, s50, v80
    v_add_f32 v81, v81, v58
    v_add_f32 v82, v82, v59
    v_cvt_pk_bf16_f32 v89, v81, v82
    v_add_f32 v60, v60, v76
    v_add_f32 v61, v61, v77
    v_add_f32 v62, v62, v78
    v_add_f32 v63, v63, v79
    v_cvt_pk_bf16_f32 v80, v60, v61
    v_lshlrev_b32 v60, 16, v80
    v_and_b32 v61, s50, v80
    v_lshlrev_b32 v81, 16, v102
    v_and_b32 v82, s50, v102
    v_mul_f32 v81, v81, v6
    v_mul_f32 v82, v82, v6
    v_cvt_pk_bf16_f32 v80, v81, v82
    v_lshlrev_b32 v81, 16, v80
    v_and_b32 v82, s50, v80
    v_add_f32 v81, v81, v60
    v_add_f32 v82, v82, v61
    v_cvt_pk_bf16_f32 v90, v81, v82
    v_cvt_pk_bf16_f32 v80, v62, v63
    v_lshlrev_b32 v62, 16, v80
    v_and_b32 v63, s50, v80
    v_lshlrev_b32 v81, 16, v103
    v_and_b32 v82, s50, v103
    v_mul_f32 v81, v81, v6
    v_mul_f32 v82, v82, v6
    v_cvt_pk_bf16_f32 v80, v81, v82
    v_lshlrev_b32 v81, 16, v80
    v_and_b32 v82, s50, v80
    v_add_f32 v81, v81, v62
    v_add_f32 v82, v82, v63
    v_cvt_pk_bf16_f32 v91, v81, v82
    s_nop 1
    v_permlane16_swap_b32 v88, v90
    v_permlane16_swap_b32 v89, v91
    buffer_store_dwordx4 v[88:91], v15, s[20:23], s6 offen offset:1024 sc1
k2_done:
    s_endpgm
.p2align 8
k3_kernel:
    s_cmp_ge_u32 s2, 256
    s_cbranch_scc1 k3_done
    s_load_dwordx2 s[8:9], s[0:1], 136
    s_load_dwordx4 s[4:7], s[0:1], 96
    s_load_dwordx2 s[28:29], s[0:1], 120
    s_and_b32 s3, s2, 7
    s_lshr_b32 s10, s2, 3
    s_and_b32 s11, s3, 1
    s_lshl_b32 s11, s11, 2
    s_and_b32 s54, s10, 3
    s_add_u32 s54, s54, s11
    s_lshr_b32 s11, s3, 1
    s_lshl_b32 s11, s11, 3
    s_lshr_b32 s55, s10, 2
    s_add_u32 s55, s55, s11
    s_mul_i32 s48, s54, 229376
    s_add_u32 s48, s48, 8978432
    s_lshl_b32 s49, s55, 7
    v_and_b32 v1, 63, v0
    v_lshrrev_b32 v2, 6, v0
    s_nop 0
    v_readfirstlane_b32 s40, v2
    v_lshlrev_b32 v3, 4, v1
    v_lshrrev_b32 v4, 3, v1
    v_and_b32 v5, 7, v1
    v_lshlrev_b32 v6, 1, v4
    v_and_b32 v6, 4, v6
    v_xor_b32 v5, v5, v6
    s_mov_b32 s41, 4096
    v_mul_lo_u32 v4, v4, s41
    v_lshl_add_u32 v4, v5, 4, v4
    v_add_u32 v5, 31744, v4
    s_mul_i32 s42, s40, 16384
    s_mul_i32 s43, s40, 57344
    s_add_u32 s43, s43, s48
    s_mul_i32 s44, s40, 1835008
    s_add_u32 s44, s44, s49
    s_waitcnt lgkmcnt(0)
    s_mov_b32 s12, s4
    s_and_b32 s13, s5, 0xffff
    s_mov_b32 s14, 7340032
    s_mov_b32 s15, 0x00020000
    s_mov_b32 s16, s6
    s_and_b32 s17, s7, 0xffff
    s_mov_b32 s18, 4096
    s_mov_b32 s19, 0x00020000
    s_mov_b32 s20, s8
    s_and_b32 s21, s9, 0xffff
    s_mov_b32 s22, 12910592
    s_mov_b32 s23, 0x00020000
    s_mov_b32 s24, s28
    s_and_b32 s25, s29, 0xffff
    s_mov_b32 s26, 2097152
    s_mov_b32 s27, 0x00020000
    s_add_u32 s45, s42, 0
    s_mov_b32 m0, s45
    s_add_u32 s45, s42, 2048
    buffer_load_dwordx4 v3, s[20:23], s43 offen lds
    buffer_load_dwordx4 v3, s[20:23], s43 offen offset:1024 lds
    s_mov_b32 m0, s45
    s_add_u32 s43, s43, 2048
    buffer_load_dwordx4 v4, s[12:15], s44 offen lds
    buffer_load_dwordx4 v5, s[12:15], s44 offen offset:1024 lds
    s_add_u32 s44, s44, 65536
    s_add_u32 s45, s42, 4096
    s_mov_b32 m0, s45
    s_add_u32 s45, s42, 6144
    buffer_load_dwordx4 v3, s[20:23], s43 offen lds
    buffer_load_dwordx4 v3, s[20:23], s43 offen offset:1024 lds
    s_mov_b32 m0, s45
    s_add_u32 s43, s43, 2048
    buffer_load_dwordx4 v4, s[12:15], s44 offen lds
    buffer_load_dwordx4 v5, s[12:15], s44 offen offset:1024 lds
    s_add_u32 s44, s44, 65536
    s_add_u32 s45, s42, 8192
    s_mov_b32 m0, s45
    s_add_u32 s45, s42, 10240
    buffer_load_dwordx4 v3, s[20:23], s43 offen lds
    buffer_load_dwordx4 v3, s[20:23], s43 offen offset:1024 lds
    s_mov_b32 m0, s45
    s_add_u32 s43, s43, 2048
    buffer_load_dwordx4 v4, s[12:15], s44 offen lds
    buffer_load_dwordx4 v5, s[12:15], s44 offen offset:1024 lds
    s_add_u32 s44, s44, 65536
    s_lshr_b32 s46, s40, 1
    s_and_b32 s47, s40, 1
    v_and_b32 v6, 31, v1
    v_lshrrev_b32 v7, 5, v1
    v_lshlrev_b32 v6, 4, v6
    v_lshl_add_u32 v6, v7, 10, v6
    s_lshl_b32 s45, s46, 9
    s_add_u32 s45, s45, s42
    v_add_u32 v6, s45, v6
    v_xor_b32 v8, 512, v6
    v_bfe_u32 v11, v1, 2, 2
    v_lshl_add_u32 v9, v7, 3, v11
    v_lshlrev_b32 v9, 7, v9
    v_lshrrev_b32 v10, 1, v11
    v_lshl_add_u32 v9, v10, 6, v9
    v_bfe_u32 v10, v1, 4, 1
    v_lshl_add_u32 v9, v10, 5, v9
    v_bfe_u32 v10, v1, 1, 1
    v_lshl_add_u32 v9, v10, 4, v9
    v_and_b32 v10, 1, v1
    v_lshl_add_u32 v9, v10, 3, v9
    s_lshl_b32 s45, s47, 6
    v_xor_b32 v9, s45, v9
    s_add_u32 s45, s42, 2048
    v_add_u32 v9, s45, v9
    v_xor_b32 v10, 64, v9
    v_mov_b32 v64, 0
    v_mov_b32 v65, 0
    v_mov_b32 v66, 0
    v_mov_b32 v67, 0
    v_mov_b32 v68, 0
    v_mov_b32 v69, 0
    v_mov_b32 v70, 0
    v_mov_b32 v71, 0
    v_mov_b32 v72, 0
    v_mov_b32 v73, 0
    v_mov_b32 v74, 0
    v_mov_b32 v75, 0
    v_mov_b32 v76, 0
    v_mov_b32 v77, 0
    v_mov_b32 v78, 0
    v_mov_b32 v79, 0
    v_mov_b32 v80, 0
    v_mov_b32 v81, 0
    v_mov_b32 v82, 0
    v_mov_b32 v83, 0
    v_mov_b32 v84, 0
    v_mov_b32 v85, 0
    v_mov_b32 v86, 0
    v_mov_b32 v87, 0
    v_mov_b32 v88, 0
    v_mov_b32 v89, 0
    v_mov_b32 v90, 0
    v_mov_b32 v91, 0
    v_mov_b32 v92, 0
    v_mov_b32 v93, 0
    v_mov_b32 v94, 0
    v_mov_b32 v95, 0
    v_mov_b32 v96, 0
    v_mov_b32 v97, 0
    v_mov_b32 v98, 0
    v_mov_b32 v99, 0
    v_mov_b32 v100, 0
    v_mov_b32 v101, 0
    v_mov_b32 v102, 0
    v_mov_b32 v103, 0
    v_mov_b32 v104, 0
    v_mov_b32 v105, 0
    v_mov_b32 v106, 0
    v_mov_b32 v107, 0
    v_mov_b32 v108, 0
    v_mov_b32 v109, 0
    v_mov_b32 v110, 0
    v_mov_b32 v111, 0
    v_mov_b32 v112, 0
    v_mov_b32 v113, 0
    v_mov_b32 v114, 0
    v_mov_b32 v115, 0
    v_mov_b32 v116, 0
    v_mov_b32 v117, 0
    v_mov_b32 v118, 0
    v_mov_b32 v119, 0
    v_mov_b32 v120, 0
    v_mov_b32 v121, 0
    v_mov_b32 v122, 0
    v_mov_b32 v123, 0
    v_mov_b32 v124, 0
    v_mov_b32 v125, 0
    v_mov_b32 v126, 0
    v_mov_b32 v127, 0
    s_waitcnt vmcnt(8)
    ds_read_b128 v[16:19], v6 offset:0
    ds_read_b128 v[20:23], v8 offset:0
    ds_read_b64_tr_b16 v[24:25], v9 offset:0
    ds_read_b64_tr_b16 v[26:27], v9 offset:512
    ds_read_b64_tr_b16 v[28:29], v10 offset:0
    ds_read_b64_tr_b16 v[30:31], v10 offset:512
    s_add_u32 s45, s42, 12288
    s_mov_b32 m0, s45
    s_add_u32 s45, s42, 14336
    buffer_load_dwordx4 v3, s[20:23], s43 offen lds
    buffer_load_dwordx4 v3, s[20:23], s43 offen offset:1024 lds
    s_mov_b32 m0, s45
    s_add_u32 s43, s43, 2048
    buffer_load_dwordx4 v4, s[12:15], s44 offen lds
    buffer_load_dwordx4 v5, s[12:15], s44 offen offset:1024 lds
    s_add_u32 s44, s44, 65536
    s_waitcnt vmcnt(8)
    ds_read_b128 v[32:35], v6 offset:4096
    ds_read_b128 v[36:39], v8 offset:4096
    ds_read_b64_tr_b16 v[40:41], v9 offset:4096
    ds_read_b64_tr_b16 v[42:43], v9 offset:4608
    ds_read_b64_tr_b16 v[44:45], v10 offset:4096
    ds_read_b64_tr_b16 v[46:47], v10 offset:4608
    s_waitcnt lgkmcnt(6)
    v_mfma_f32_32x32x16_bf16 v[64:79], v[16:19], v[24:27], v[64:79]
    v_mfma_f32_32x32x16_bf16 v[80:95], v[16:19], v[28:31], v[80:95]
    v_mfma_f32_32x32x16_bf16 v[96:111], v[20:23], v[24:27], v[96:111]
    v_mfma_f32_32x32x16_bf16 v[112:127], v[20:23], v[28:31], v[112:127]
    s_add_u32 s45, s42, 0
    s_mov_b32 m0, s45
    s_add_u32 s45, s42, 2048
    buffer_load_dwordx4 v3, s[20:23], s43 offen lds
    buffer_load_dwordx4 v3, s[20:23], s43 offen offset:1024 lds
    s_mov_b32 m0, s45
    s_add_u32 s43, s43, 2048
    buffer_load_dwordx4 v4, s[12:15], s44 offen lds
    buffer_load_dwordx4 v5, s[12:15], s44 offen offset:1024 lds
    s_add_u32 s44, s44, 65536
    s_waitcnt vmcnt(8)
    ds_read_b128 v[16:19], v6 offset:8192
    ds_read_b128 v[20:23], v8 offset:8192
    ds_read_b64_tr_b16 v[24:25], v9 offset:8192
    ds_read_b64_tr_b16 v[26:27], v9 offset:8704
    ds_read_b64_tr_b16 v[28:29], v10 offset:8192
    ds_read_b64_tr_b16 v[30:31], v10 offset:8704
    s_waitcnt lgkmcnt(6)
    v_mfma_f32_32x32x16_bf16 v[64:79], v[32:35], v[40:43], v[64:79]
    v_mfma_f32_32x32x16_bf16 v[80:95], v[32:35], v[44:47], v[80:95]
    v_mfma_f32_32x32x16_bf16 v[96:111], v[36:39], v[40:43], v[96:111]
    v_mfma_f32_32x32x16_bf16 v[112:127], v[36:39], v[44:47], v[112:127]
    s_add_u32 s45, s42, 4096
    s_mov_b32 m0, s45
    s_add_u32 s45, s42, 6144
    buffer_load_dwordx4 v3, s[20:23], s43 offen lds
    buffer_load_dwordx4 v3, s[20:23], s43 offen offset:1024 lds
    s_mov_b32 m0, s45
    s_add_u32 s43, s43, 2048
    buffer_load_dwordx4 v4, s[12:15], s44 offen lds
    buffer_load_dwordx4 v5, s[12:15], s44 offen offset:1024 lds
    s_add_u32 s44, s44, 65536
    s_and_b32 s53, s40, 1
    s_lshl_b32 s53, s53, 6
    s_add_u32 s53, s53, s49
    v_and_b32 v12, 31, v1
    v_lshlrev_b32 v13, 1, v12
    buffer_load_ushort v48, v13, s[16:19], s53 offen
    s_lshl_b32 s51, s53, 1
    s_add_u32 s51, s51, 4194304
    v_lshlrev_b32 v14, 2, v12
    buffer_load_dword v49, v14, s[20:23], s51 offen
    v_lshrrev_b32 v14, 5, v1
    v_lshl_add_u32 v13, v14, 14, v13
    s_lshr_b32 s51, s40, 1
    s_lshl_b32 s51, s51, 5
    s_lshl_b32 s52, s54, 6
    s_add_u32 s51, s51, s52
    s_lshl_b32 s51, s51, 12
    s_add_u32 s51, s51, s53
    s_add_u32 s51, s51, 10813440
    buffer_load_ushort v128, v13, s[20:23], s51 offen
    s_add_u32 s51, s51, 4096
    buffer_load_ushort v129, v13, s[20:23], s51 offen
    s_add_u32 s51, s51, 4096
    buffer_load_ushort v130, v13, s[20:23], s51 offen
    s_add_u32 s51, s51, 4096
    buffer_load_ushort v131, v13, s[20:23], s51 offen
    s_add_u32 s51, s51, 20480
    buffer_load_ushort v132, v13, s[20:23], s51 offen
    s_add_u32 s51, s51, 4096
    buffer_load_ushort v133, v13, s[20:23], s51 offen
    s_add_u32 s51, s51, 4096
    buffer_load_ushort v134, v13, s[20:23], s51 offen
    s_add_u32 s51, s51, 4096
    buffer_load_ushort v135, v13, s[20:23], s51 offen
    s_add_u32 s51, s51, 20480
    buffer_load_ushort v136, v13, s[20:23], s51 offen
    s_add_u32 s51, s51, 4096
    buffer_load_ushort v137, v13, s[20:23], s51 offen
    s_add_u32 s51, s51, 4096
    buffer_load_ushort v138, v13, s[20:23], s51 offen
    s_add_u32 s51, s51, 4096
    buffer_load_ushort v139, v13, s[20:23], s51 offen
    s_add_u32 s51, s51, 20480
    buffer_load_ushort v140, v13, s[20:23], s51 offen
    s_add_u32 s51, s51, 4096
    buffer_load_ushort v141, v13, s[20:23], s51 offen
    s_add_u32 s51, s51, 4096
    buffer_load_ushort v142, v13, s[20:23], s51 offen
    s_add_u32 s51, s51, 4096
    buffer_load_ushort v143, v13, s[20:23], s51 offen
    s_add_u32 s51, s51, 20480
    s_waitcnt vmcnt(26)
    ds_read_b128 v[32:35], v6 offset:12288
    ds_read_b128 v[36:39], v8 offset:12288
    ds_read_b64_tr_b16 v[40:41], v9 offset:12288
    ds_read_b64_tr_b16 v[42:43], v9 offset:12800
    ds_read_b64_tr_b16 v[44:45], v10 offset:12288
    ds_read_b64_tr_b16 v[46:47], v10 offset:12800
    s_waitcnt lgkmcnt(6)
    v_mfma_f32_32x32x16_bf16 v[64:79], v[16:19], v[24:27], v[64:79]
    v_mfma_f32_32x32x16_bf16 v[80:95], v[16:19], v[28:31], v[80:95]
    v_mfma_f32_32x32x16_bf16 v[96:111], v[20:23], v[24:27], v[96:111]
    v_mfma_f32_32x32x16_bf16 v[112:127], v[20:23], v[28:31], v[112:127]
    s_add_u32 s45, s42, 8192
    s_mov_b32 m0, s45
    s_add_u32 s45, s42, 10240
    buffer_load_dwordx4 v3, s[20:23], s43 offen lds
    buffer_load_dwordx4 v3, s[20:23], s43 offen offset:1024 lds
    s_mov_b32 m0, s45
    s_add_u32 s43, s43, 2048
    buffer_load_dwordx4 v4, s[12:15], s44 offen lds
    buffer_load_dwordx4 v5, s[12:15], s44 offen offset:1024 lds
    s_add_u32 s44, s44, 65536
    s_waitcnt vmcnt(26)
    ds_read_b128 v[16:19], v6 offset:0
    ds_read_b128 v[20:23], v8 offset:0
    ds_read_b64_tr_b16 v[24:25], v9 offset:0
    ds_read_b64_tr_b16 v[26:27], v9 offset:512
    ds_read_b64_tr_b16 v[28:29], v10 offset:0
    ds_read_b64_tr_b16 v[30:31], v10 offset:512
    s_waitcnt lgkmcnt(6)
    v_mfma_f32_32x32x16_bf16 v[64:79], v[32:35], v[40:43], v[64:79]
    v_mfma_f32_32x32x16_bf16 v[80:95], v[32:35], v[44:47], v[80:95]
    v_mfma_f32_32x32x16_bf16 v[96:111], v[36:39], v[40:43], v[96:111]
    v_mfma_f32_32x32x16_bf16 v[112:127], v[36:39], v[44:47], v[112:127]
    s_add_u32 s45, s42, 12288
    s_mov_b32 m0, s45
    s_add_u32 s45, s42, 14336
    buffer_load_dwordx4 v3, s[20:23], s43 offen lds
    buffer_load_dwordx4 v3, s[20:23], s43 offen offset:1024 lds
    s_mov_b32 m0, s45
    s_add_u32 s43, s43, 2048
    buffer_load_dwordx4 v4, s[12:15], s44 offen lds
    buffer_load_dwordx4 v5, s[12:15], s44 offen offset:1024 lds
    s_add_u32 s44, s44, 65536
    s_waitcnt vmcnt(26)
    ds_read_b128 v[32:35], v6 offset:4096
    ds_read_b128 v[36:39], v8 offset:4096
    ds_read_b64_tr_b16 v[40:41], v9 offset:4096
    ds_read_b64_tr_b16 v[42:43], v9 offset:4608
    ds_read_b64_tr_b16 v[44:45], v10 offset:4096
    ds_read_b64_tr_b16 v[46:47], v10 offset:4608
    s_waitcnt lgkmcnt(6)
    v_mfma_f32_32x32x16_bf16 v[64:79], v[16:19], v[24:27], v[64:79]
    v_mfma_f32_32x32x16_bf16 v[80:95], v[16:19], v[28:31], v[80:95]
    v_mfma_f32_32x32x16_bf16 v[96:111], v[20:23], v[24:27], v[96:111]
    v_mfma_f32_32x32x16_bf16 v[112:127], v[20:23], v[28:31], v[112:127]
    s_add_u32 s45, s42, 0
    s_mov_b32 m0, s45
    s_add_u32 s45, s42, 2048
    buffer_load_dwordx4 v3, s[20:23], s43 offen lds
    buffer_load_dwordx4 v3, s[20:23], s43 offen offset:1024 lds
    s_mov_b32 m0, s45
    s_add_u32 s43, s43, 2048
    buffer_load_dwordx4 v4, s[12:15], s44 offen lds
    buffer_load_dwordx4 v5, s[12:15], s44 offen offset:1024 lds
    s_add_u32 s44, s44, 65536
    s_waitcnt vmcnt(8)
    ds_read_b128 v[16:19], v6 offset:8192
    ds_read_b128 v[20:23], v8 offset:8192
    ds_read_b64_tr_b16 v[24:25], v9 offset:8192
    ds_read_b64_tr_b16 v[26:27], v9 offset:8704
    ds_read_b64_tr_b16 v[28:29], v10 offset:8192
    ds_read_b64_tr_b16 v[30:31], v10 offset:8704
    s_waitcnt lgkmcnt(6)
    v_mfma_f32_32x32x16_bf16 v[64:79], v[32:35], v[40:43], v[64:79]
    v_mfma_f32_32x32x16_bf16 v[80:95], v[32:35], v[44:47], v[80:95]
    v_mfma_f32_32x32x16_bf16 v[96:111], v[36:39], v[40:43], v[96:111]
    v_mfma_f32_32x32x16_bf16 v[112:127], v[36:39], v[44:47], v[112:127]
    s_add_u32 s45, s42, 4096
    s_mov_b32 m0, s45
    s_add_u32 s45, s42, 6144
    buffer_load_dwordx4 v3, s[20:23], s43 offen lds
    buffer_load_dwordx4 v3, s[20:23], s43 offen offset:1024 lds
    s_mov_b32 m0, s45
    s_add_u32 s43, s43, 2048
    buffer_load_dwordx4 v4, s[12:15], s44 offen lds
    buffer_load_dwordx4 v5, s[12:15], s44 offen offset:1024 lds
    s_add_u32 s44, s44, 65536
    s_waitcnt vmcnt(8)
    ds_read_b128 v[32:35], v6 offset:12288
    ds_read_b128 v[36:39], v8 offset:12288
    ds_read_b64_tr_b16 v[40:41], v9 offset:12288
    ds_read_b64_tr_b16 v[42:43], v9 offset:12800
    ds_read_b64_tr_b16 v[44:45], v10 offset:12288
    ds_read_b64_tr_b16 v[46:47], v10 offset:12800
    s_waitcnt lgkmcnt(6)
    v_mfma_f32_32x32x16_bf16 v[64:79], v[16:19], v[24:27], v[64:79]
    v_mfma_f32_32x32x16_bf16 v[80:95], v[16:19], v[28:31], v[80:95]
    v_mfma_f32_32x32x16_bf16 v[96:111], v[20:23], v[24:27], v[96:111]
    v_mfma_f32_32x32x16_bf16 v[112:127], v[20:23], v[28:31], v[112:127]
    s_add_u32 s45, s42, 8192
    s_mov_b32 m0, s45
    s_add_u32 s45, s42, 10240
    buffer_load_dwordx4 v3, s[20:23], s43 offen lds
    buffer_load_dwordx4 v3, s[20:23], s43 offen offset:1024 lds
    s_mov_b32 m0, s45
    s_add_u32 s43, s43, 2048
    buffer_load_dwordx4 v4, s[12:15], s44 offen lds
    buffer_load_dwordx4 v5, s[12:15], s44 offen offset:1024 lds
    s_add_u32 s44, s44, 65536
    s_waitcnt vmcnt(8)
    ds_read_b128 v[16:19], v6 offset:0
    ds_read_b128 v[20:23], v8 offset:0
    ds_read_b64_tr_b16 v[24:25], v9 offset:0
    ds_read_b64_tr_b16 v[26:27], v9 offset:512
    ds_read_b64_tr_b16 v[28:29], v10 offset:0
    ds_read_b64_tr_b16 v[30:31], v10 offset:512
    s_waitcnt lgkmcnt(6)
    v_mfma_f32_32x32x16_bf16 v[64:79], v[32:35], v[40:43], v[64:79]
    v_mfma_f32_32x32x16_bf16 v[80:95], v[32:35], v[44:47], v[80:95]
    v_mfma_f32_32x32x16_bf16 v[96:111], v[36:39], v[40:43], v[96:111]
    v_mfma_f32_32x32x16_bf16 v[112:127], v[36:39], v[44:47], v[112:127]
    s_add_u32 s45, s42, 12288
    s_mov_b32 m0, s45
    s_add_u32 s45, s42, 14336
    buffer_load_dwordx4 v3, s[20:23], s43 offen lds
    buffer_load_dwordx4 v3, s[20:23], s43 offen offset:1024 lds
    s_mov_b32 m0, s45
    s_add_u32 s43, s43, 2048
    buffer_load_dwordx4 v4, s[12:15], s44 offen lds
    buffer_load_dwordx4 v5, s[12:15], s44 offen offset:1024 lds
    s_add_u32 s44, s44, 65536
    s_waitcnt vmcnt(8)
    ds_read_b128 v[32:35], v6 offset:4096
    ds_read_b128 v[36:39], v8 offset:4096
    ds_read_b64_tr_b16 v[40:41], v9 offset:4096
    ds_read_b64_tr_b16 v[42:43], v9 offset:4608
    ds_read_b64_tr_b16 v[44:45], v10 offset:4096
    ds_read_b64_tr_b16 v[46:47], v10 offset:4608
    s_waitcnt lgkmcnt(6)
    v_mfma_f32_32x32x16_bf16 v[64:79], v[16:19], v[24:27], v[64:79]
    v_mfma_f32_32x32x16_bf16 v[80:95], v[16:19], v[28:31], v[80:95]
    v_mfma_f32_32x32x16_bf16 v[96:111], v[20:23], v[24:27], v[96:111]
    v_mfma_f32_32x32x16_bf16 v[112:127], v[20:23], v[28:31], v[112:127]
    s_add_u32 s45, s42, 0
    s_mov_b32 m0, s45
    s_add_u32 s45, s42, 2048
    buffer_load_dwordx4 v3, s[20:23], s43 offen lds
    buffer_load_dwordx4 v3, s[20:23], s43 offen offset:1024 lds
    s_mov_b32 m0, s45
    s_add_u32 s43, s43, 2048
    buffer_load_dwordx4 v4, s[12:15], s44 offen lds
    buffer_load_dwordx4 v5, s[12:15], s44 offen offset:1024 lds
    s_add_u32 s44, s44, 65536
    s_waitcnt vmcnt(8)
    ds_read_b128 v[16:19], v6 offset:8192
    ds_read_b128 v[20:23], v8 offset:8192
    ds_read_b64_tr_b16 v[24:25], v9 offset:8192
    ds_read_b64_tr_b16 v[26:27], v9 offset:8704
    ds_read_b64_tr_b16 v[28:29], v10 offset:8192
    ds_read_b64_tr_b16 v[30:31], v10 offset:8704
    s_waitcnt lgkmcnt(6)
    v_mfma_f32_32x32x16_bf16 v[64:79], v[32:35], v[40:43], v[64:79]
    v_mfma_f32_32x32x16_bf16 v[80:95], v[32:35], v[44:47], v[80:95]
    v_mfma_f32_32x32x16_bf16 v[96:111], v[36:39], v[40:43], v[96:111]
    v_mfma_f32_32x32x16_bf16 v[112:127], v[36:39], v[44:47], v[112:127]
    s_add_u32 s45, s42, 4096
    s_mov_b32 m0, s45
    s_add_u32 s45, s42, 6144
    buffer_load_dwordx4 v3, s[20:23], s43 offen lds
    buffer_load_dwordx4 v3, s[20:23], s43 offen offset:1024 lds
    s_mov_b32 m0, s45
    s_add_u32 s43, s43, 2048
    buffer_load_dwordx4 v4, s[12:15], s44 offen lds
    buffer_load_dwordx4 v5, s[12:15], s44 offen offset:1024 lds
    s_add_u32 s44, s44, 65536
    s_waitcnt vmcnt(8)
    ds_read_b128 v[32:35], v6 offset:12288
    ds_read_b128 v[36:39], v8 offset:12288
    ds_read_b64_tr_b16 v[40:41], v9 offset:12288
    ds_read_b64_tr_b16 v[42:43], v9 offset:12800
    ds_read_b64_tr_b16 v[44:45], v10 offset:12288
    ds_read_b64_tr_b16 v[46:47], v10 offset:12800
    s_waitcnt lgkmcnt(6)
    v_mfma_f32_32x32x16_bf16 v[64:79], v[16:19], v[24:27], v[64:79]
    v_mfma_f32_32x32x16_bf16 v[80:95], v[16:19], v[28:31], v[80:95]
    v_mfma_f32_32x32x16_bf16 v[96:111], v[20:23], v[24:27], v[96:111]
    v_mfma_f32_32x32x16_bf16 v[112:127], v[20:23], v[28:31], v[112:127]
    s_add_u32 s45, s42, 8192
    s_mov_b32 m0, s45
    s_add_u32 s45, s42, 10240
    buffer_load_dwordx4 v3, s[20:23], s43 offen lds
    buffer_load_dwordx4 v3, s[20:23], s43 offen offset:1024 lds
    s_mov_b32 m0, s45
    s_add_u32 s43, s43, 2048
    buffer_load_dwordx4 v4, s[12:15], s44 offen lds
    buffer_load_dwordx4 v5, s[12:15], s44 offen offset:1024 lds
    s_add_u32 s44, s44, 65536
    s_waitcnt vmcnt(8)
    ds_read_b128 v[16:19], v6 offset:0
    ds_read_b128 v[20:23], v8 offset:0
    ds_read_b64_tr_b16 v[24:25], v9 offset:0
    ds_read_b64_tr_b16 v[26:27], v9 offset:512
    ds_read_b64_tr_b16 v[28:29], v10 offset:0
    ds_read_b64_tr_b16 v[30:31], v10 offset:512
    s_waitcnt lgkmcnt(6)
    v_mfma_f32_32x32x16_bf16 v[64:79], v[32:35], v[40:43], v[64:79]
    v_mfma_f32_32x32x16_bf16 v[80:95], v[32:35], v[44:47], v[80:95]
    v_mfma_f32_32x32x16_bf16 v[96:111], v[36:39], v[40:43], v[96:111]
    v_mfma_f32_32x32x16_bf16 v[112:127], v[36:39], v[44:47], v[112:127]
    s_add_u32 s45, s42, 12288
    s_mov_b32 m0, s45
    s_add_u32 s45, s42, 14336
    buffer_load_dwordx4 v3, s[20:23], s43 offen lds
    buffer_load_dwordx4 v3, s[20:23], s43 offen offset:1024 lds
    s_mov_b32 m0, s45
    s_add_u32 s43, s43, 2048
    buffer_load_dwordx4 v4, s[12:15], s44 offen lds
    buffer_load_dwordx4 v5, s[12:15], s44 offen offset:1024 lds
    s_add_u32 s44, s44, 65536
    s_waitcnt vmcnt(8)
    ds_read_b128 v[32:35], v6 offset:4096
    ds_read_b128 v[36:39], v8 offset:4096
    ds_read_b64_tr_b16 v[40:41], v9 offset:4096
    ds_read_b64_tr_b16 v[42:43], v9 offset:4608
    ds_read_b64_tr_b16 v[44:45], v10 offset:4096
    ds_read_b64_tr_b16 v[46:47], v10 offset:4608
    s_waitcnt lgkmcnt(6)
    v_mfma_f32_32x32x16_bf16 v[64:79], v[16:19], v[24:27], v[64:79]
    v_mfma_f32_32x32x16_bf16 v[80:95], v[16:19], v[28:31], v[80:95]
    v_mfma_f32_32x32x16_bf16 v[96:111], v[20:23], v[24:27], v[96:111]
    v_mfma_f32_32x32x16_bf16 v[112:127], v[20:23], v[28:31], v[112:127]
    s_add_u32 s45, s42, 0
    s_mov_b32 m0, s45
    s_add_u32 s45, s42, 2048
    buffer_load_dwordx4 v3, s[20:23], s43 offen lds
    buffer_load_dwordx4 v3, s[20:23], s43 offen offset:1024 lds
    s_mov_b32 m0, s45
    s_add_u32 s43, s43, 2048
    buffer_load_dwordx4 v4, s[12:15], s44 offen lds
    buffer_load_dwordx4 v5, s[12:15], s44 offen offset:1024 lds
    s_add_u32 s44, s44, 65536
    s_waitcnt vmcnt(8)
    ds_read_b128 v[16:19], v6 offset:8192
    ds_read_b128 v[20:23], v8 offset:8192
    ds_read_b64_tr_b16 v[24:25], v9 offset:8192
    ds_read_b64_tr_b16 v[26:27], v9 offset:8704
    ds_read_b64_tr_b16 v[28:29], v10 offset:8192
    ds_read_b64_tr_b16 v[30:31], v10 offset:8704
    s_waitcnt lgkmcnt(6)
    v_mfma_f32_32x32x16_bf16 v[64:79], v[32:35], v[40:43], v[64:79]
    v_mfma_f32_32x32x16_bf16 v[80:95], v[32:35], v[44:47], v[80:95]
    v_mfma_f32_32x32x16_bf16 v[96:111], v[36:39], v[40:43], v[96:111]
    v_mfma_f32_32x32x16_bf16 v[112:127], v[36:39], v[44:47], v[112:127]
    s_add_u32 s45, s42, 4096
    s_mov_b32 m0, s45
    s_add_u32 s45, s42, 6144
    buffer_load_dwordx4 v3, s[20:23], s43 offen lds
    buffer_load_dwordx4 v3, s[20:23], s43 offen offset:1024 lds
    s_mov_b32 m0, s45
    s_add_u32 s43, s43, 2048
    buffer_load_dwordx4 v4, s[12:15], s44 offen lds
    buffer_load_dwordx4 v5, s[12:15], s44 offen offset:1024 lds
    s_add_u32 s44, s44, 65536
    s_waitcnt vmcnt(8)
    ds_read_b128 v[32:35], v6 offset:12288
    ds_read_b128 v[36:39], v8 offset:12288
    ds_read_b64_tr_b16 v[40:41], v9 offset:12288
    ds_read_b64_tr_b16 v[42:43], v9 offset:12800
    ds_read_b64_tr_b16 v[44:45], v10 offset:12288
    ds_read_b64_tr_b16 v[46:47], v10 offset:12800
    s_waitcnt lgkmcnt(6)
    v_mfma_f32_32x32x16_bf16 v[64:79], v[16:19], v[24:27], v[64:79]
    v_mfma_f32_32x32x16_bf16 v[80:95], v[16:19], v[28:31], v[80:95]
    v_mfma_f32_32x32x16_bf16 v[96:111], v[20:23], v[24:27], v[96:111]
    v_mfma_f32_32x32x16_bf16 v[112:127], v[20:23], v[28:31], v[112:127]
    s_add_u32 s45, s42, 8192
    s_mov_b32 m0, s45
    s_add_u32 s45, s42, 10240
    buffer_load_dwordx4 v3, s[20:23], s43 offen lds
    buffer_load_dwordx4 v3, s[20:23], s43 offen offset:1024 lds
    s_mov_b32 m0, s45
    s_add_u32 s43, s43, 2048
    buffer_load_dwordx4 v4, s[12:15], s44 offen lds
    buffer_load_dwordx4 v5, s[12:15], s44 offen offset:1024 lds
    s_add_u32 s44, s44, 65536
    s_waitcnt vmcnt(8)
    ds_read_b128 v[16:19], v6 offset:0
    ds_read_b128 v[20:23], v8 offset:0
    ds_read_b64_tr_b16 v[24:25], v9 offset:0
    ds_read_b64_tr_b16 v[26:27], v9 offset:512
    ds_read_b64_tr_b16 v[28:29], v10 offset:0
    ds_read_b64_tr_b16 v[30:31], v10 offset:512
    s_waitcnt lgkmcnt(6)
    v_mfma_f32_32x32x16_bf16 v[64:79], v[32:35], v[40:43], v[64:79]
    v_mfma_f32_32x32x16_bf16 v[80:95], v[32:35], v[44:47], v[80:95]
    v_mfma_f32_32x32x16_bf16 v[96:111], v[36:39], v[40:43], v[96:111]
    v_mfma_f32_32x32x16_bf16 v[112:127], v[36:39], v[44:47], v[112:127]
    s_add_u32 s45, s42, 12288
    s_mov_b32 m0, s45
    s_add_u32 s45, s42, 14336
    buffer_load_dwordx4 v3, s[20:23], s43 offen lds
    buffer_load_dwordx4 v3, s[20:23], s43 offen offset:1024 lds
    s_mov_b32 m0, s45
    s_add_u32 s43, s43, 2048
    buffer_load_dwordx4 v4, s[12:15], s44 offen lds
    buffer_load_dwordx4 v5, s[12:15], s44 offen offset:1024 lds
    s_add_u32 s44, s44, 65536
    s_waitcnt vmcnt(8)
    ds_read_b128 v[32:35], v6 offset:4096
    ds_read_b128 v[36:39], v8 offset:4096
    ds_read_b64_tr_b16 v[40:41], v9 offset:4096
    ds_read_b64_tr_b16 v[42:43], v9 offset:4608
    ds_read_b64_tr_b16 v[44:45], v10 offset:4096
    ds_read_b64_tr_b16 v[46:47], v10 offset:4608
    s_waitcnt lgkmcnt(6)
    v_mfma_f32_32x32x16_bf16 v[64:79], v[16:19], v[24:27], v[64:79]
    v_mfma_f32_32x32x16_bf16 v[80:95], v[16:19], v[28:31], v[80:95]
    v_mfma_f32_32x32x16_bf16 v[96:111], v[20:23], v[24:27], v[96:111]
    v_mfma_f32_32x32x16_bf16 v[112:127], v[20:23], v[28:31], v[112:127]
    s_add_u32 s45, s42, 0
    s_mov_b32 m0, s45
    s_add_u32 s45, s42, 2048
    buffer_load_dwordx4 v3, s[20:23], s43 offen lds
    buffer_load_dwordx4 v3, s[20:23], s43 offen offset:1024 lds
    s_mov_b32 m0, s45
    s_add_u32 s43, s43, 2048
    buffer_load_dwordx4 v4, s[12:15], s44 offen lds
    buffer_load_dwordx4 v5, s[12:15], s44 offen offset:1024 lds
    s_add_u32 s44, s44, 65536
    s_waitcnt vmcnt(8)
    ds_read_b128 v[16:19], v6 offset:8192
    ds_read_b128 v[20:23], v8 offset:8192
    ds_read_b64_tr_b16 v[24:25], v9 offset:8192
    ds_read_b64_tr_b16 v[26:27], v9 offset:8704
    ds_read_b64_tr_b16 v[28:29], v10 offset:8192
    ds_read_b64_tr_b16 v[30:31], v10 offset:8704
    s_waitcnt lgkmcnt(6)
    v_mfma_f32_32x32x16_bf16 v[64:79], v[32:35], v[40:43], v[64:79]
    v_mfma_f32_32x32x16_bf16 v[80:95], v[32:35], v[44:47], v[80:95]
    v_mfma_f32_32x32x16_bf16 v[96:111], v[36:39], v[40:43], v[96:111]
    v_mfma_f32_32x32x16_bf16 v[112:127], v[36:39], v[44:47], v[112:127]
    s_add_u32 s45, s42, 4096
    s_mov_b32 m0, s45
    s_add_u32 s45, s42, 6144
    buffer_load_dwordx4 v3, s[20:23], s43 offen lds
    buffer_load_dwordx4 v3, s[20:23], s43 offen offset:1024 lds
    s_mov_b32 m0, s45
    s_add_u32 s43, s43, 2048
    buffer_load_dwordx4 v4, s[12:15], s44 offen lds
    buffer_load_dwordx4 v5, s[12:15], s44 offen offset:1024 lds
    s_add_u32 s44, s44, 65536
    s_waitcnt vmcnt(8)
    ds_read_b128 v[32:35], v6 offset:12288
    ds_read_b128 v[36:39], v8 offset:12288
    ds_read_b64_tr_b16 v[40:41], v9 offset:12288
    ds_read_b64_tr_b16 v[42:43], v9 offset:12800
    ds_read_b64_tr_b16 v[44:45], v10 offset:12288
    ds_read_b64_tr_b16 v[46:47], v10 offset:12800
    s_waitcnt lgkmcnt(6)
    v_mfma_f32_32x32x16_bf16 v[64:79], v[16:19], v[24:27], v[64:79]
    v_mfma_f32_32x32x16_bf16 v[80:95], v[16:19], v[28:31], v[80:95]
    v_mfma_f32_32x32x16_bf16 v[96:111], v[20:23], v[24:27], v[96:111]
    v_mfma_f32_32x32x16_bf16 v[112:127], v[20:23], v[28:31], v[112:127]
    s_add_u32 s45, s42, 8192
    s_mov_b32 m0, s45
    s_add_u32 s45, s42, 10240
    buffer_load_dwordx4 v3, s[20:23], s43 offen lds
    buffer_load_dwordx4 v3, s[20:23], s43 offen offset:1024 lds
    s_mov_b32 m0, s45
    s_add_u32 s43, s43, 2048
    buffer_load_dwordx4 v4, s[12:15], s44 offen lds
    buffer_load_dwordx4 v5, s[12:15], s44 offen offset:1024 lds
    s_add_u32 s44, s44, 65536
    s_waitcnt vmcnt(8)
    ds_read_b128 v[16:19], v6 offset:0
    ds_read_b128 v[20:23], v8 offset:0
    ds_read_b64_tr_b16 v[24:25], v9 offset:0
    ds_read_b64_tr_b16 v[26:27], v9 offset:512
    ds_read_b64_tr_b16 v[28:29], v10 offset:0
    ds_read_b64_tr_b16 v[30:31], v10 offset:512
    s_waitcnt lgkmcnt(6)
    v_mfma_f32_32x32x16_bf16 v[64:79], v[32:35], v[40:43], v[64:79]
    v_mfma_f32_32x32x16_bf16 v[80:95], v[32:35], v[44:47], v[80:95]
    v_mfma_f32_32x32x16_bf16 v[96:111], v[36:39], v[40:43], v[96:111]
    v_mfma_f32_32x32x16_bf16 v[112:127], v[36:39], v[44:47], v[112:127]
    s_add_u32 s45, s42, 12288
    s_mov_b32 m0, s45
    s_add_u32 s45, s42, 14336
    buffer_load_dwordx4 v3, s[20:23], s43 offen lds
    buffer_load_dwordx4 v3, s[20:23], s43 offen offset:1024 lds
    s_mov_b32 m0, s45
    s_add_u32 s43, s43, 2048
    buffer_load_dwordx4 v4, s[12:15], s44 offen lds
    buffer_load_dwordx4 v5, s[12:15], s44 offen offset:1024 lds
    s_add_u32 s44, s44, 65536
    s_waitcnt vmcnt(8)
    ds_read_b128 v[32:35], v6 offset:4096
    ds_read_b128 v[36:39], v8 offset:4096
    ds_read_b64_tr_b16 v[40:41], v9 offset:4096
    ds_read_b64_tr_b16 v[42:43], v9 offset:4608
    ds_read_b64_tr_b16 v[44:45], v10 offset:4096
    ds_read_b64_tr_b16 v[46:47], v10 offset:4608
    s_waitcnt lgkmcnt(6)
    v_mfma_f32_32x32x16_bf16 v[64:79], v[16:19], v[24:27], v[64:79]
    v_mfma_f32_32x32x16_bf16 v[80:95], v[16:19], v[28:31], v[80:95]
    v_mfma_f32_32x32x16_bf16 v[96:111], v[20:23], v[24:27], v[96:111]
    v_mfma_f32_32x32x16_bf16 v[112:127], v[20:23], v[28:31], v[112:127]
    s_add_u32 s45, s42, 0
    s_mov_b32 m0, s45
    s_add_u32 s45, s42, 2048
    buffer_load_dwordx4 v3, s[20:23], s43 offen lds
    buffer_load_dwordx4 v3, s[20:23], s43 offen offset:1024 lds
    s_mov_b32 m0, s45
    s_add_u32 s43, s43, 2048
    buffer_load_dwordx4 v4, s[12:15], s44 offen lds
    buffer_load_dwordx4 v5, s[12:15], s44 offen offset:1024 lds
    s_add_u32 s44, s44, 65536
    s_waitcnt vmcnt(8)
    ds_read_b128 v[16:19], v6 offset:8192
    ds_read_b128 v[20:23], v8 offset:8192
    ds_read_b64_tr_b16 v[24:25], v9 offset:8192
    ds_read_b64_tr_b16 v[26:27], v9 offset:8704
    ds_read_b64_tr_b16 v[28:29], v10 offset:8192
    ds_read_b64_tr_b16 v[30:31], v10 offset:8704
    s_waitcnt lgkmcnt(6)
    v_mfma_f32_32x32x16_bf16 v[64:79], v[32:35], v[40:43], v[64:79]
    v_mfma_f32_32x32x16_bf16 v[80:95], v[32:35], v[44:47], v[80:95]
    v_mfma_f32_32x32x16_bf16 v[96:111], v[36:39], v[40:43], v[96:111]
    v_mfma_f32_32x32x16_bf16 v[112:127], v[36:39], v[44:47], v[112:127]
    s_add_u32 s45, s42, 4096
    s_mov_b32 m0, s45
    s_add_u32 s45, s42, 6144
    buffer_load_dwordx4 v3, s[20:23], s43 offen lds
    buffer_load_dwordx4 v3, s[20:23], s43 offen offset:1024 lds
    s_mov_b32 m0, s45
    s_add_u32 s43, s43, 2048
    buffer_load_dwordx4 v4, s[12:15], s44 offen lds
    buffer_load_dwordx4 v5, s[12:15], s44 offen offset:1024 lds
    s_add_u32 s44, s44, 65536
    s_waitcnt vmcnt(8)
    ds_read_b128 v[32:35], v6 offset:12288
    ds_read_b128 v[36:39], v8 offset:12288
    ds_read_b64_tr_b16 v[40:41], v9 offset:12288
    ds_read_b64_tr_b16 v[42:43], v9 offset:12800
    ds_read_b64_tr_b16 v[44:45], v10 offset:12288
    ds_read_b64_tr_b16 v[46:47], v10 offset:12800
    s_waitcnt lgkmcnt(6)
    v_mfma_f32_32x32x16_bf16 v[64:79], v[16:19], v[24:27], v[64:79]
    v_mfma_f32_32x32x16_bf16 v[80:95], v[16:19], v[28:31], v[80:95]
    v_mfma_f32_32x32x16_bf16 v[96:111], v[20:23], v[24:27], v[96:111]
    v_mfma_f32_32x32x16_bf16 v[112:127], v[20:23], v[28:31], v[112:127]
    s_add_u32 s45, s42, 8192
    s_mov_b32 m0, s45
    s_add_u32 s45, s42, 10240
    buffer_load_dwordx4 v3, s[20:23], s43 offen lds
    buffer_load_dwordx4 v3, s[20:23], s43 offen offset:1024 lds
    s_mov_b32 m0, s45
    s_add_u32 s43, s43, 2048
    buffer_load_dwordx4 v4, s[12:15], s44 offen lds
    buffer_load_dwordx4 v5, s[12:15], s44 offen offset:1024 lds
    s_add_u32 s44, s44, 65536
    s_waitcnt vmcnt(8)
    ds_read_b128 v[16:19], v6 offset:0
    ds_read_b128 v[20:23], v8 offset:0
    ds_read_b64_tr_b16 v[24:25], v9 offset:0
    ds_read_b64_tr_b16 v[26:27], v9 offset:512
    ds_read_b64_tr_b16 v[28:29], v10 offset:0
    ds_read_b64_tr_b16 v[30:31], v10 offset:512
    s_waitcnt lgkmcnt(6)
    v_mfma_f32_32x32x16_bf16 v[64:79], v[32:35], v[40:43], v[64:79]
    v_mfma_f32_32x32x16_bf16 v[80:95], v[32:35], v[44:47], v[80:95]
    v_mfma_f32_32x32x16_bf16 v[96:111], v[36:39], v[40:43], v[96:111]
    v_mfma_f32_32x32x16_bf16 v[112:127], v[36:39], v[44:47], v[112:127]
    s_add_u32 s45, s42, 12288
    s_mov_b32 m0, s45
    s_add_u32 s45, s42, 14336
    buffer_load_dwordx4 v3, s[20:23], s43 offen lds
    buffer_load_dwordx4 v3, s[20:23], s43 offen offset:1024 lds
    s_mov_b32 m0, s45
    s_add_u32 s43, s43, 2048
    buffer_load_dwordx4 v4, s[12:15], s44 offen lds
    buffer_load_dwordx4 v5, s[12:15], s44 offen offset:1024 lds
    s_add_u32 s44, s44, 65536
    s_waitcnt vmcnt(8)
    ds_read_b128 v[32:35], v6 offset:4096
    ds_read_b128 v[36:39], v8 offset:4096
    ds_read_b64_tr_b16 v[40:41], v9 offset:4096
    ds_read_b64_tr_b16 v[42:43], v9 offset:4608
    ds_read_b64_tr_b16 v[44:45], v10 offset:4096
    ds_read_b64_tr_b16 v[46:47], v10 offset:4608
    s_waitcnt lgkmcnt(6)
    v_mfma_f32_32x32x16_bf16 v[64:79], v[16:19], v[24:27], v[64:79]
    v_mfma_f32_32x32x16_bf16 v[80:95], v[16:19], v[28:31], v[80:95]
    v_mfma_f32_32x32x16_bf16 v[96:111], v[20:23], v[24:27], v[96:111]
    v_mfma_f32_32x32x16_bf16 v[112:127], v[20:23], v[28:31], v[112:127]
    s_waitcnt vmcnt(4)
    ds_read_b128 v[16:19], v6 offset:8192
    ds_read_b128 v[20:23], v8 offset:8192
    ds_read_b64_tr_b16 v[24:25], v9 offset:8192
    ds_read_b64_tr_b16 v[26:27], v9 offset:8704
    ds_read_b64_tr_b16 v[28:29], v10 offset:8192
    ds_read_b64_tr_b16 v[30:31], v10 offset:8704
    s_waitcnt lgkmcnt(6)
    v_mfma_f32_32x32x16_bf16 v[64:79], v[32:35], v[40:43], v[64:79]
    v_mfma_f32_32x32x16_bf16 v[80:95], v[32:35], v[44:47], v[80:95]
    v_mfma_f32_32x32x16_bf16 v[96:111], v[36:39], v[40:43], v[96:111]
    v_mfma_f32_32x32x16_bf16 v[112:127], v[36:39], v[44:47], v[112:127]
    s_waitcnt vmcnt(0)
    ds_read_b128 v[32:35], v6 offset:12288
    ds_read_b128 v[36:39], v8 offset:12288
    ds_read_b64_tr_b16 v[40:41], v9 offset:12288
    ds_read_b64_tr_b16 v[42:43], v9 offset:12800
    ds_read_b64_tr_b16 v[44:45], v10 offset:12288
    ds_read_b64_tr_b16 v[46:47], v10 offset:12800
    s_waitcnt lgkmcnt(6)
    v_mfma_f32_32x32x16_bf16 v[64:79], v[16:19], v[24:27], v[64:79]
    v_mfma_f32_32x32x16_bf16 v[80:95], v[16:19], v[28:31], v[80:95]
    v_mfma_f32_32x32x16_bf16 v[96:111], v[20:23], v[24:27], v[96:111]
    v_mfma_f32_32x32x16_bf16 v[112:127], v[20:23], v[28:31], v[112:127]
    s_waitcnt lgkmcnt(0)
    v_mfma_f32_32x32x16_bf16 v[64:79], v[32:35], v[40:43], v[64:79]
    v_mfma_f32_32x32x16_bf16 v[80:95], v[32:35], v[44:47], v[80:95]
    v_mfma_f32_32x32x16_bf16 v[96:111], v[36:39], v[40:43], v[96:111]
    v_mfma_f32_32x32x16_bf16 v[112:127], v[36:39], v[44:47], v[112:127]
    v_lshlrev_b32 v15, 4, v1
    v_add_u32 v2, s42, v15
    s_nop 9
    ds_write_b128 v2, v[80:83] offset:0
    ds_write_b128 v2, v[84:87] offset:1024
    ds_write_b128 v2, v[88:91] offset:2048
    ds_write_b128 v2, v[92:95] offset:3072
    ds_write_b128 v2, v[96:99] offset:4096
    ds_write_b128 v2, v[100:103] offset:5120
    ds_write_b128 v2, v[104:107] offset:6144
    ds_write_b128 v2, v[108:111] offset:7168
    ds_write_b128 v2, v[112:115] offset:8192
    ds_write_b128 v2, v[116:119] offset:9216
    ds_write_b128 v2, v[120:123] offset:10240
    ds_write_b128 v2, v[124:127] offset:11264
    s_xor_b32 s45, s40, 1
    s_mul_i32 s45, s45, 16384
    v_add_u32 v17, s45, v15
    s_xor_b32 s45, s40, 2
    s_mul_i32 s45, s45, 16384
    v_add_u32 v18, s45, v15
    s_xor_b32 s45, s40, 3
    s_mul_i32 s45, s45, 16384
    v_add_u32 v19, s45, v15
    s_waitcnt lgkmcnt(0)
    s_barrier
    ds_read_b128 v[80:83], v17 offset:0
    ds_read_b128 v[84:87], v17 offset:1024
    ds_read_b128 v[88:91], v17 offset:2048
    ds_read_b128 v[92:95], v17 offset:3072
    ds_read_b128 v[96:99], v18 offset:4096
    ds_read_b128 v[100:103], v18 offset:5120
    ds_read_b128 v[104:107], v18 offset:6144
    ds_read_b128 v[108:111], v18 offset:7168
    ds_read_b128 v[112:115], v19 offset:8192
    ds_read_b128 v[116:119], v19 offset:9216
    ds_read_b128 v[120:123], v19 offset:10240
    ds_read_b128 v[124:127], v19 offset:11264
    s_waitcnt lgkmcnt(8)
    v_add_f32 v64, v64, v80
    v_add_f32 v65, v65, v81
    v_add_f32 v66, v66, v82
    v_add_f32 v67, v67, v83
    v_add_f32 v68, v68, v84
    v_add_f32 v69, v69, v85
    v_add_f32 v70, v70, v86
    v_add_f32 v71, v71, v87
    v_add_f32 v72, v72, v88
    v_add_f32 v73, v73, v89
    v_add_f32 v74, v74, v90
    v_add_f32 v75, v75, v91
    v_add_f32 v76, v76, v92
    v_add_f32 v77, v77, v93
    v_add_f32 v78, v78, v94
    v_add_f32 v79, v79, v95
    s_waitcnt lgkmcnt(4)
    v_add_f32 v64, v64, v96
    v_add_f32 v65, v65, v97
    v_add_f32 v66, v66, v98
    v_add_f32 v67, v67, v99
    v_add_f32 v68, v68, v100
    v_add_f32 v69, v69, v101
    v_add_f32 v70, v70, v102
    v_add_f32 v71, v71, v103
    v_add_f32 v72, v72, v104
    v_add_f32 v73, v73, v105
    v_add_f32 v74, v74, v106
    v_add_f32 v75, v75, v107
    v_add_f32 v76, v76, v108
    v_add_f32 v77, v77, v109
    v_add_f32 v78, v78, v110
    v_add_f32 v79, v79, v111
    s_waitcnt lgkmcnt(0)
    v_add_f32 v64, v64, v112
    v_add_f32 v65, v65, v113
    v_add_f32 v66, v66, v114
    v_add_f32 v67, v67, v115
    v_add_f32 v68, v68, v116
    v_add_f32 v69, v69, v117
    v_add_f32 v70, v70, v118
    v_add_f32 v71, v71, v119
    v_add_f32 v72, v72, v120
    v_add_f32 v73, v73, v121
    v_add_f32 v74, v74, v122
    v_add_f32 v75, v75, v123
    v_add_f32 v76, v76, v124
    v_add_f32 v77, v77, v125
    v_add_f32 v78, v78, v126
    v_add_f32 v79, v79, v127
    s_mov_b32 s50, 0xffff0000
    v_lshlrev_b32 v48, 16, v48
    v_sub_f32 v50, 1.0, v49
    v_cvt_pk_bf16_f32 v50, v50, v50
    v_lshlrev_b32 v50, 16, v50
    v_cvt_pk_bf16_f32 v40, v64, v65
    v_lshlrev_b32 v64, 16, v40
    v_and_b32 v65, s50, v40
    v_add_f32 v64, v64, v48
    v_add_f32 v65, v65, v48
    v_cvt_pk_bf16_f32 v40, v64, v65
    v_lshlrev_b32 v64, 16, v40
    v_and_b32 v65, s50, v40
    v_lshlrev_b32 v41, 16, v128
    v_lshlrev_b32 v42, 16, v129
    v_mul_f32 v41, v49, v41
    v_mul_f32 v42, v49, v42
    v_cvt_pk_bf16_f32 v40, v41, v42
    v_lshlrev_b32 v41, 16, v40
    v_and_b32 v42, s50, v40
    v_mul_f32 v64, v50, v64
    v_mul_f32 v65, v50, v65
    v_cvt_pk_bf16_f32 v40, v64, v65
    v_lshlrev_b32 v64, 16, v40
    v_and_b32 v65, s50, v40
    v_add_f32 v41, v41, v64
    v_add_f32 v42, v42, v65
    v_cvt_pk_bf16_f32 v56, v41, v42
    v_cvt_pk_bf16_f32 v40, v66, v67
    v_lshlrev_b32 v66, 16, v40
    v_and_b32 v67, s50, v40
    v_add_f32 v66, v66, v48
    v_add_f32 v67, v67, v48
    v_cvt_pk_bf16_f32 v40, v66, v67
    v_lshlrev_b32 v66, 16, v40
    v_and_b32 v67, s50, v40
    v_lshlrev_b32 v41, 16, v130
    v_lshlrev_b32 v42, 16, v131
    v_mul_f32 v41, v49, v41
    v_mul_f32 v42, v49, v42
    v_cvt_pk_bf16_f32 v40, v41, v42
    v_lshlrev_b32 v41, 16, v40
    v_and_b32 v42, s50, v40
    v_mul_f32 v66, v50, v66
    v_mul_f32 v67, v50, v67
    v_cvt_pk_bf16_f32 v40, v66, v67
    v_lshlrev_b32 v66, 16, v40
    v_and_b32 v67, s50, v40
    v_add_f32 v41, v41, v66
    v_add_f32 v42, v42, v67
    v_cvt_pk_bf16_f32 v57, v41, v42
    v_cvt_pk_bf16_f32 v40, v68, v69
    v_lshlrev_b32 v68, 16, v40
    v_and_b32 v69, s50, v40
    v_add_f32 v68, v68, v48
    v_add_f32 v69, v69, v48
    v_cvt_pk_bf16_f32 v40, v68, v69
    v_lshlrev_b32 v68, 16, v40
    v_and_b32 v69, s50, v40
    v_lshlrev_b32 v41, 16, v132
    v_lshlrev_b32 v42, 16, v133
    v_mul_f32 v41, v49, v41
    v_mul_f32 v42, v49, v42
    v_cvt_pk_bf16_f32 v40, v41, v42
    v_lshlrev_b32 v41, 16, v40
    v_and_b32 v42, s50, v40
    v_mul_f32 v68, v50, v68
    v_mul_f32 v69, v50, v69
    v_cvt_pk_bf16_f32 v40, v68, v69
    v_lshlrev_b32 v68, 16, v40
    v_and_b32 v69, s50, v40
    v_add_f32 v41, v41, v68
    v_add_f32 v42, v42, v69
    v_cvt_pk_bf16_f32 v58, v41, v42
    v_cvt_pk_bf16_f32 v40, v70, v71
    v_lshlrev_b32 v70, 16, v40
    v_and_b32 v71, s50, v40
    v_add_f32 v70, v70, v48
    v_add_f32 v71, v71, v48
    v_cvt_pk_bf16_f32 v40, v70, v71
    v_lshlrev_b32 v70, 16, v40
    v_and_b32 v71, s50, v40
    v_lshlrev_b32 v41, 16, v134
    v_lshlrev_b32 v42, 16, v135
    v_mul_f32 v41, v49, v41
    v_mul_f32 v42, v49, v42
    v_cvt_pk_bf16_f32 v40, v41, v42
    v_lshlrev_b32 v41, 16, v40
    v_and_b32 v42, s50, v40
    v_mul_f32 v70, v50, v70
    v_mul_f32 v71, v50, v71
    v_cvt_pk_bf16_f32 v40, v70, v71
    v_lshlrev_b32 v70, 16, v40
    v_and_b32 v71, s50, v40
    v_add_f32 v41, v41, v70
    v_add_f32 v42, v42, v71
    v_cvt_pk_bf16_f32 v59, v41, v42
    v_cvt_pk_bf16_f32 v40, v72, v73
    v_lshlrev_b32 v72, 16, v40
    v_and_b32 v73, s50, v40
    v_add_f32 v72, v72, v48
    v_add_f32 v73, v73, v48
    v_cvt_pk_bf16_f32 v40, v72, v73
    v_lshlrev_b32 v72, 16, v40
    v_and_b32 v73, s50, v40
    v_lshlrev_b32 v41, 16, v136
    v_lshlrev_b32 v42, 16, v137
    v_mul_f32 v41, v49, v41
    v_mul_f32 v42, v49, v42
    v_cvt_pk_bf16_f32 v40, v41, v42
    v_lshlrev_b32 v41, 16, v40
    v_and_b32 v42, s50, v40
    v_mul_f32 v72, v50, v72
    v_mul_f32 v73, v50, v73
    v_cvt_pk_bf16_f32 v40, v72, v73
    v_lshlrev_b32 v72, 16, v40
    v_and_b32 v73, s50, v40
    v_add_f32 v41, v41, v72
    v_add_f32 v42, v42, v73
    v_cvt_pk_bf16_f32 v60, v41, v42
    v_cvt_pk_bf16_f32 v40, v74, v75
    v_lshlrev_b32 v74, 16, v40
    v_and_b32 v75, s50, v40
    v_add_f32 v74, v74, v48
    v_add_f32 v75, v75, v48
    v_cvt_pk_bf16_f32 v40, v74, v75
    v_lshlrev_b32 v74, 16, v40
    v_and_b32 v75, s50, v40
    v_lshlrev_b32 v41, 16, v138
    v_lshlrev_b32 v42, 16, v139
    v_mul_f32 v41, v49, v41
    v_mul_f32 v42, v49, v42
    v_cvt_pk_bf16_f32 v40, v41, v42
    v_lshlrev_b32 v41, 16, v40
    v_and_b32 v42, s50, v40
    v_mul_f32 v74, v50, v74
    v_mul_f32 v75, v50, v75
    v_cvt_pk_bf16_f32 v40, v74, v75
    v_lshlrev_b32 v74, 16, v40
    v_and_b32 v75, s50, v40
    v_add_f32 v41, v41, v74
    v_add_f32 v42, v42, v75
    v_cvt_pk_bf16_f32 v61, v41, v42
    v_cvt_pk_bf16_f32 v40, v76, v77
    v_lshlrev_b32 v76, 16, v40
    v_and_b32 v77, s50, v40
    v_add_f32 v76, v76, v48
    v_add_f32 v77, v77, v48
    v_cvt_pk_bf16_f32 v40, v76, v77
    v_lshlrev_b32 v76, 16, v40
    v_and_b32 v77, s50, v40
    v_lshlrev_b32 v41, 16, v140
    v_lshlrev_b32 v42, 16, v141
    v_mul_f32 v41, v49, v41
    v_mul_f32 v42, v49, v42
    v_cvt_pk_bf16_f32 v40, v41, v42
    v_lshlrev_b32 v41, 16, v40
    v_and_b32 v42, s50, v40
    v_mul_f32 v76, v50, v76
    v_mul_f32 v77, v50, v77
    v_cvt_pk_bf16_f32 v40, v76, v77
    v_lshlrev_b32 v76, 16, v40
    v_and_b32 v77, s50, v40
    v_add_f32 v41, v41, v76
    v_add_f32 v42, v42, v77
    v_cvt_pk_bf16_f32 v62, v41, v42
    v_cvt_pk_bf16_f32 v40, v78, v79
    v_lshlrev_b32 v78, 16, v40
    v_and_b32 v79, s50, v40
    v_add_f32 v78, v78, v48
    v_add_f32 v79, v79, v48
    v_cvt_pk_bf16_f32 v40, v78, v79
    v_lshlrev_b32 v78, 16, v40
    v_and_b32 v79, s50, v40
    v_lshlrev_b32 v41, 16, v142
    v_lshlrev_b32 v42, 16, v143
    v_mul_f32 v41, v49, v41
    v_mul_f32 v42, v49, v42
    v_cvt_pk_bf16_f32 v40, v41, v42
    v_lshlrev_b32 v41, 16, v40
    v_and_b32 v42, s50, v40
    v_mul_f32 v78, v50, v78
    v_mul_f32 v79, v50, v79
    v_cvt_pk_bf16_f32 v40, v78, v79
    v_lshlrev_b32 v78, 16, v40
    v_and_b32 v79, s50, v40
    v_add_f32 v41, v41, v78
    v_add_f32 v42, v42, v79
    v_cvt_pk_bf16_f32 v63, v41, v42
    s_lshl_b32 s51, s55, 16
    s_lshl_b32 s52, s47, 15
    s_add_u32 s51, s51, s52
    s_lshl_b32 s52, s54, 7
    s_add_u32 s51, s51, s52
    s_lshl_b32 s52, s46, 6
    s_add_u32 s51, s51, s52
    v_lshlrev_b32 v13, 10, v12
    v_lshl_add_u32 v13, v14, 4, v13
    v_permlane32_swap_b32 v56, v58
    v_permlane32_swap_b32 v57, v59
    v_permlane32_swap_b32 v60, v62
    v_permlane32_swap_b32 v61, v63
    buffer_store_dwordx4 v[56:59], v13, s[24:27], s51 offen offset:0
    buffer_store_dwordx4 v[60:63], v13, s[24:27], s51 offen offset:32
k3_done:
    s_endpgm
.section .rodata,"a"
.p2align 6
.amdhsa_kernel k1_kernel
  .amdhsa_next_free_vgpr 136
  .amdhsa_next_free_sgpr 96
  .amdhsa_accum_offset 136
  .amdhsa_group_segment_fixed_size 0
  .amdhsa_kernarg_size 144
  .amdhsa_user_sgpr_count 2
  .amdhsa_user_sgpr_kernarg_segment_ptr 1
  .amdhsa_system_sgpr_workgroup_id_x 1
.end_amdhsa_kernel
.p2align 6
.amdhsa_kernel k2_kernel
  .amdhsa_next_free_vgpr 244
  .amdhsa_next_free_sgpr 96
  .amdhsa_accum_offset 244
  .amdhsa_group_segment_fixed_size 0
  .amdhsa_kernarg_size 144
  .amdhsa_user_sgpr_count 2
  .amdhsa_user_sgpr_kernarg_segment_ptr 1
  .amdhsa_system_sgpr_workgroup_id_x 1
.end_amdhsa_kernel
.p2align 6
.amdhsa_kernel k3_kernel
  .amdhsa_next_free_vgpr 144
  .amdhsa_next_free_sgpr 96
  .amdhsa_accum_offset 144
  .amdhsa_group_segment_fixed_size 0
  .amdhsa_kernarg_size 144
  .amdhsa_user_sgpr_count 2
  .amdhsa_user_sgpr_kernarg_segment_ptr 1
  .amdhsa_system_sgpr_workgroup_id_x 1
.end_amdhsa_kernel
```
